```python
import torch

def _softmax(x, axis=-1):
    return torch.softmax(x, dim=axis)
def _gelu(x):
    return torch.nn.functional.gelu(x, approximate="tanh")
def _silu(x):
    return torch.nn.functional.silu(x)
def _sigmoid(x):
    return torch.sigmoid(x)
def _layernorm(x, axis=-1, eps=1e-5):
    m = x.mean(dim=axis, keepdim=True)
    v = x.var(dim=axis, keepdim=True, unbiased=False)
    return (x - m) / torch.sqrt(v + eps)
def _scatter_add(tgt, idx, src, axis=0):
    return tgt.clone().index_add_(axis, idx, src)
def _segment_sum(src, seg, n):
    out = torch.zeros((n,) + src.shape[1:], dtype=src.dtype)
    return out.index_add_(0, seg, src)
def _pad(x, pw):
    flat = tuple(v for pair in reversed(pw) for v in pair)
    return torch.nn.functional.pad(x, flat)

kernel_name = 'sequential_preLN__grouped_kv_mqa__dense_activation_relu__prompt'

def setup_inputs():

    _w = (lambda a: (lambda t: t.to(torch.bfloat16) if t.is_floating_point() else t)(torch.as_tensor(a)))
    def _A_setup():
        B, S, D, H = 1, 2048, 512, 32
        Dh = D // H
        return {
            "x": _w((lambda *s: torch.randn(*s, dtype=torch.bfloat16) * 0.05)(B, S, D)),
            "wq": _w((lambda *s: torch.randn(*s, dtype=torch.bfloat16) * 0.05)(D, H * Dh)),
            "wk": _w((lambda *s: torch.randn(*s, dtype=torch.bfloat16) * 0.05)(D, Dh)),
            "wv": _w((lambda *s: torch.randn(*s, dtype=torch.bfloat16) * 0.05)(D, Dh)),
            "wo": _w((lambda *s: torch.randn(*s, dtype=torch.bfloat16) * 0.05)(H * Dh, D)),
        }
    _A_in = _A_setup()

    def _B_setup():
        B, S, D, Dff = 1, 2048, 512, 1792
        return {
            "x": _w((lambda *s: torch.randn(*s, dtype=torch.bfloat16) * 0.05)(B, S, D)),
            "w1": _w((lambda *s: torch.randn(*s, dtype=torch.bfloat16) * 0.05)(D, Dff)),
            "w2": _w((lambda *s: torch.randn(*s, dtype=torch.bfloat16) * 0.05)(Dff, D)),
        }
    _B_in = _B_setup()

    return {
        "A_x": _A_in["x"],
        "A_wq": _A_in["wq"],
        "A_wk": _A_in["wk"],
        "A_wv": _A_in["wv"],
        "A_wo": _A_in["wo"],
        "B_x": _B_in["x"],
        "B_w1": _B_in["w1"],
        "B_w2": _B_in["w2"],
    }

def reference(A_x, A_wq, A_wk, A_wv, A_wo, B_x, B_w1, B_w2):
    def _A_ref(x, wq, wk, wv, wo):
        B, S, D = x.shape
        H = 32
        Dh = D // H
        q = (lambda x, *d: x.permute(*d))((x @ wq).reshape(B, S, H, Dh), 0, 2, 1, 3)
        k = x @ wk
        v = x @ wv
        scores = torch.einsum("bhqd,bkd->bhqk", q, k) * (Dh ** -0.5)
        p = _softmax(scores, axis=-1)
        o = torch.einsum("bhqk,bkd->bhqd", p, v)
        return (lambda x, *d: x.permute(*d))(o, 0, 2, 1, 3).reshape(B, S, H * Dh) @ wo

    def _B_ref(x, w1, w2):
        h = torch.einsum("bsd,df->bsf", x, w1)
        zero = torch.zeros_like(h)
        h = torch.maximum(h, zero)
        return torch.einsum("bsf,fd->bsd", h, w2)

    x = A_x
    h = x + _A_ref(_layernorm(x, axis=-1), A_wq, A_wk, A_wv, A_wo)
    h2 = h + _B_ref(_layernorm(h, axis=-1), B_w1, B_w2)
    return h2
```

```asm
; @launch grid=(256,1,1) block=(512,1,1) lds=163840
.amdgcn_target "amdgcn-amd-amdhsa--gfx950"
.text
.globl sequential_preLN__grouped_kv_mqa__dense_activation_relu__prompt_kernel
.p2align 8
.type sequential_preLN__grouped_kv_mqa__dense_activation_relu__prompt_kernel,@function
sequential_preLN__grouped_kv_mqa__dense_activation_relu__prompt_kernel:
    s_cmp_ge_u32 s2, 0x100
    s_cbranch_scc1 L_end
    s_load_dwordx16 s[40:55], s[0:1], 0
    s_load_dwordx4 s[56:59], s[0:1], 64
    s_load_dwordx2 s[60:61], s[0:1], 80
    s_getpc_b64 s[96:97]
L_pc:
    v_lshrrev_b32 v10, 6, v0
    v_and_b32 v11, 7, v0
    v_lshl_add_u32 v11, v10, 3, v11
    s_lshr_b32 s77, s2, 3
    s_lshl_b32 s77, s77, 4
    v_readfirstlane_b32 s64, v10
    v_bfe_u32 v12, v0, 3, 1
    v_lshl_add_u32 v12, v10, 1, v12
    v_add3_u32 v12, s77, v12, 64
    v_and_b32 v0, 63, v0
    v_cmp_gt_u32 vcc, 32, v0
    v_lshlrev_b32 v1, 4, v0
    s_nop 0
    v_cndmask_b32 v11, v12, v11, vcc
    v_lshlrev_b32 v11, 7, v11
    v_min_u32 v11, L_end-L_pc, v11
    global_load_dword v143, v11, s[96:97]
    s_and_b32 s62, s2, 7
    s_lshl_b32 s62, s62, 2
    s_lshr_b32 s76, s2, 6
    s_add_u32 s62, s62, s76
    s_bfe_u32 s63, s2, 0x30003
    s_lshr_b32 s72, s63, 1
    s_lshl_b32 s72, s72, 4
    s_lshl_b32 s76, s64, 1
    s_add_u32 s80, s76, s72
    s_lshl_b32 s78, s62, 16
    s_lshl_b32 s77, s80, 10
    s_add_u32 s77, s77, s78
    s_mul_i32 s76, s80, 1040
    s_lshl_b32 s79, s64, 11
    s_mov_b32 s10, 0x200000
    s_mov_b32 s11, 0x20000
    s_mov_b32 s18, 0x4000
    s_mov_b32 s19, 0x20000
    s_mov_b32 m0, s76
    s_bitcmp1_b32 s63, 0
    s_waitcnt lgkmcnt(0)
    s_mov_b32 s8, s40
    s_mov_b32 s9, s41
    s_cselect_b32 s16, s46, s44
    s_cselect_b32 s17, s47, s45
    buffer_load_dwordx4 v1, s[8:11], s77 offen lds
    s_add_u32 m0, s76, 1040
    s_add_u32 s77, s77, 1024
    buffer_load_dwordx4 v1, s[8:11], s77 offen lds
    s_add_u32 m0, s79, 132096
    s_nop 0
    buffer_load_dwordx4 v1, s[16:19], s79 offen lds
    buffer_load_dwordx4 v1, s[16:19], s79 offen offset:1024 lds
    s_load_dword s86, s[60:61], 0
    s_and_b32 s65, s64, 1
    s_lshr_b32 s68, s64, 1
    s_and_b32 s66, s68, 1
    s_lshr_b32 s67, s64, 2
    v_lshrrev_b32 v10, 3, v0
    v_lshrrev_b32 v11, 2, v0
    v_and_b32 v11, 4, v11
    v_and_b32 v12, 7, v0
    v_xor_b32 v11, v11, v12
    v_lshlrev_b32 v11, 4, v11
    v_lshl_add_u32 v2, v10, 10, v11
    s_mov_b32 s12, s42
    s_mov_b32 s13, s43
    s_mov_b32 s14, 0x80000
    s_mov_b32 s15, 0x20000
    s_lshl_b32 s74, s64, 14
    s_lshl_b32 s75, s63, 7
    s_and_b32 s76, s2, 7
    s_lshl_b32 s76, s76, 11
    s_add_u32 s74, s74, s76
    s_mov_b32 s71, 0x3f803f80
    s_mov_b32 s92, s71
    s_mov_b32 s93, s71
    s_lshl_b32 s85, s64, 13
    s_sub_u32 s81, s64, s67
    s_lshl_b32 s81, s81, 3
    s_add_u32 s81, s81, s72
    s_add_u32 s81, s81, 8
    s_and_b32 s81, s81, 63
    s_cmp_eq_u32 s67, 0
    s_cbranch_scc1 L_kv
    s_and_b32 s74, s74, 0xffff
    s_add_u32 m0, s74, 66560
    s_lshl3_add_u32 s77, s74, s75
    s_add_u32 s74, s74, 1024
    buffer_load_dwordx4 v2, s[12:15], s77 offen lds
    s_and_b32 s74, s74, 0xffff
    s_add_u32 m0, s74, 66560
    s_lshl3_add_u32 s77, s74, s75
    s_add_u32 s74, s74, 1024
    buffer_load_dwordx4 v2, s[12:15], s77 offen lds
    s_mov_b32 s36, s60
    s_mov_b32 s37, s61
    s_mov_b32 s38, 0x1000000
    s_mov_b32 s39, 0x20000
    s_mov_b32 s20, s48
    s_mov_b32 s21, s49
    s_mov_b32 s22, 0x80000
    s_mov_b32 s23, 0x20000
    s_mov_b32 s24, s52
    s_mov_b32 s25, s53
    s_mov_b32 s26, 0x1c0000
    s_mov_b32 s27, 0x20000
    s_mov_b32 s28, s54
    s_mov_b32 s29, s55
    s_mov_b32 s30, 0x1c0000
    s_mov_b32 s31, 0x20000
    s_mov_b32 s32, s56
    s_mov_b32 s33, s57
    s_mov_b32 s34, 0x200000
    s_mov_b32 s35, 0x20000
    s_and_b32 s74, s74, 0xffff
    s_add_u32 m0, s74, 66560
    s_lshl3_add_u32 s77, s74, s75
    s_add_u32 s74, s74, 1024
    buffer_load_dwordx4 v2, s[12:15], s77 offen lds
    s_and_b32 s74, s74, 0xffff
    s_add_u32 m0, s74, 66560
    s_lshl3_add_u32 s77, s74, s75
    s_add_u32 s74, s74, 1024
    buffer_load_dwordx4 v2, s[12:15], s77 offen lds
    s_and_b32 s74, s74, 0xffff
    s_add_u32 m0, s74, 66560
    s_lshl3_add_u32 s77, s74, s75
    s_add_u32 s74, s74, 1024
    buffer_load_dwordx4 v2, s[12:15], s77 offen lds
    s_and_b32 s74, s74, 0xffff
    s_add_u32 m0, s74, 66560
    s_lshl3_add_u32 s77, s74, s75
    s_add_u32 s74, s74, 1024
    buffer_load_dwordx4 v2, s[12:15], s77 offen lds
    s_and_b32 s74, s74, 0xffff
    s_add_u32 m0, s74, 66560
    s_lshl3_add_u32 s77, s74, s75
    s_add_u32 s74, s74, 1024
    buffer_load_dwordx4 v2, s[12:15], s77 offen lds
    s_and_b32 s74, s74, 0xffff
    s_add_u32 m0, s74, 66560
    s_lshl3_add_u32 s77, s74, s75
    s_add_u32 s74, s74, 1024
    buffer_load_dwordx4 v2, s[12:15], s77 offen lds
    s_waitcnt vmcnt(8)
    s_barrier
    s_and_b32 s74, s74, 0xffff
    s_add_u32 m0, s74, 66560
    s_lshl3_add_u32 s77, s74, s75
    s_add_u32 s74, s74, 1024
    buffer_load_dwordx4 v2, s[12:15], s77 offen lds
    s_and_b32 s74, s74, 0xffff
    s_add_u32 m0, s74, 66560
    s_lshl3_add_u32 s77, s74, s75
    s_add_u32 s74, s74, 1024
    buffer_load_dwordx4 v2, s[12:15], s77 offen lds
    s_and_b32 s74, s74, 0xffff
    s_add_u32 m0, s74, 66560
    s_lshl3_add_u32 s77, s74, s75
    s_add_u32 s74, s74, 1024
    buffer_load_dwordx4 v2, s[12:15], s77 offen lds
    s_and_b32 s74, s74, 0xffff
    s_add_u32 m0, s74, 66560
    s_lshl3_add_u32 s77, s74, s75
    s_add_u32 s74, s74, 1024
    buffer_load_dwordx4 v2, s[12:15], s77 offen lds
    s_and_b32 s74, s74, 0xffff
    s_add_u32 m0, s74, 66560
    s_lshl3_add_u32 s77, s74, s75
    s_add_u32 s74, s74, 1024
    buffer_load_dwordx4 v2, s[12:15], s77 offen lds
    s_and_b32 s74, s74, 0xffff
    s_add_u32 m0, s74, 66560
    s_lshl3_add_u32 s77, s74, s75
    s_add_u32 s74, s74, 1024
    buffer_load_dwordx4 v2, s[12:15], s77 offen lds
    s_and_b32 s74, s74, 0xffff
    s_add_u32 m0, s74, 66560
    s_lshl3_add_u32 s77, s74, s75
    s_add_u32 s74, s74, 1024
    buffer_load_dwordx4 v2, s[12:15], s77 offen lds
    s_and_b32 s74, s74, 0xffff
    s_add_u32 m0, s74, 66560
    s_lshl3_add_u32 s77, s74, s75
    s_add_u32 s74, s74, 1024
    buffer_load_dwordx4 v2, s[12:15], s77 offen lds
    s_barrier
    s_cmp_eq_u32 s64, 4
    s_cbranch_scc1 L_fin
    s_branch L_xrest
L_kv:
    v_and_b32 v10, 15, v0
    v_add_u32 v11, s72, v10
    v_mul_u32_u24 v232, 1040, v11
    v_lshrrev_b32 v11, 4, v0
    s_lshl_b32 s77, s64, 8
    v_lshl_add_u32 v232, v11, 4, v232
    v_add_u32 v232, s77, v232
    v_lshlrev_b32 v12, 3, v10
    v_lshl_add_u32 v233, v11, 8, v12
    s_lshl_b32 s79, s64, 12
    s_add_u32 s79, s79, 132096
    v_add_u32 v233, s79, v233
    v_add_u32 v234, s79, v1
    s_lshl_b32 s77, s64, 9
    s_add_u32 s77, s77, 148480
    v_lshl_add_u32 v235, v0, 3, s77
    v_mov_b64 v[224:225], s[92:93]
    v_mov_b64 v[226:227], s[92:93]
    v_mov_b32 v49, 0
    v_mov_b32 v50, 0
    v_and_b32 v12, 1, v11
    v_lshlrev_b32 v12, 8, v12
    v_lshl_add_u32 v12, v10, 4, v12
    v_lshrrev_b32 v13, 1, v11
    v_lshl_add_u32 v12, v13, 3, v12
    v_lshrrev_b32 v13, 3, v10
    v_lshlrev_b32 v13, 8, v13
    v_lshl_add_u32 v13, v11, 6, v13
    v_and_b32 v14, 7, v10
    v_lshl_add_u32 v13, v14, 1, v13
    s_bitcmp1_b32 s63, 0
    s_cselect_b64 vcc, -1, 0
    s_cselect_b32 s77, 16, 2
    v_cndmask_b32 v228, v12, v13, vcc
    v_add_u32 v228, 152576, v228
    v_add_u32 v229, s77, v228
    v_add_u32 v230, s77, v229
    v_add_u32 v231, s77, v230
    v_add_u32 v236, 152576, v1
    s_mov_b32 s36, s60
    s_mov_b32 s37, s61
    s_mov_b32 s38, 0x1000000
    s_mov_b32 s39, 0x20000
    s_mov_b32 s20, s48
    s_mov_b32 s21, s49
    s_mov_b32 s22, 0x80000
    s_mov_b32 s23, 0x20000
    s_mov_b32 s24, s52
    s_mov_b32 s25, s53
    s_mov_b32 s26, 0x1c0000
    s_mov_b32 s27, 0x20000
    s_mov_b32 s28, s54
    s_mov_b32 s29, s55
    s_mov_b32 s30, 0x1c0000
    s_mov_b32 s31, 0x20000
    s_mov_b32 s32, s56
    s_mov_b32 s33, s57
    s_mov_b32 s34, 0x200000
    s_mov_b32 s35, 0x20000
    s_waitcnt vmcnt(0)
    s_barrier
    ds_read_b128 v[144:147], v232 offset:0
    ds_read_b64_tr_b16 v[168:169], v233 offset:0
    ds_read_b64_tr_b16 v[170:171], v233 offset:128
    ds_read_b128 v[148:151], v232 offset:64
    ds_read_b64_tr_b16 v[172:173], v233 offset:1024
    ds_read_b64_tr_b16 v[174:175], v233 offset:1152
    ds_read_b128 v[152:155], v232 offset:128
    ds_read_b64_tr_b16 v[176:177], v233 offset:2048
    ds_read_b64_tr_b16 v[178:179], v233 offset:2176
    ds_read_b128 v[156:159], v232 offset:192
    ds_read_b64_tr_b16 v[180:181], v233 offset:3072
    ds_read_b64_tr_b16 v[182:183], v233 offset:3200
    s_waitcnt lgkmcnt(0)
    v_mfma_f32_16x16x32_bf16 v[40:43], v[168:171], v[144:147], 0
    v_mfma_f32_16x16x32_bf16 v[52:55], v[224:227], v[144:147], 0
    v_mfma_f32_16x16x32_bf16 v[44:47], v[168:171], v[224:227], 0
    v_dot2_f32_bf16 v49, v144, v144, v49
    v_dot2_f32_bf16 v50, v145, v145, v50
    v_dot2_f32_bf16 v49, v146, v146, v49
    v_dot2_f32_bf16 v50, v147, v147, v50
    v_mfma_f32_16x16x32_bf16 v[40:43], v[172:175], v[148:151], v[40:43]
    v_mfma_f32_16x16x32_bf16 v[52:55], v[224:227], v[148:151], v[52:55]
    v_mfma_f32_16x16x32_bf16 v[44:47], v[172:175], v[224:227], v[44:47]
    v_dot2_f32_bf16 v49, v148, v148, v49
    v_dot2_f32_bf16 v50, v149, v149, v50
    v_dot2_f32_bf16 v49, v150, v150, v49
    v_dot2_f32_bf16 v50, v151, v151, v50
    v_mfma_f32_16x16x32_bf16 v[40:43], v[176:179], v[152:155], v[40:43]
    v_mfma_f32_16x16x32_bf16 v[52:55], v[224:227], v[152:155], v[52:55]
    v_mfma_f32_16x16x32_bf16 v[44:47], v[176:179], v[224:227], v[44:47]
    v_dot2_f32_bf16 v49, v152, v152, v49
    v_dot2_f32_bf16 v50, v153, v153, v50
    v_dot2_f32_bf16 v49, v154, v154, v49
    v_dot2_f32_bf16 v50, v155, v155, v50
    v_mfma_f32_16x16x32_bf16 v[40:43], v[180:183], v[156:159], v[40:43]
    v_mfma_f32_16x16x32_bf16 v[52:55], v[224:227], v[156:159], v[52:55]
    v_mfma_f32_16x16x32_bf16 v[44:47], v[180:183], v[224:227], v[44:47]
    v_dot2_f32_bf16 v49, v156, v156, v49
    v_dot2_f32_bf16 v50, v157, v157, v50
    v_dot2_f32_bf16 v49, v158, v158, v49
    v_dot2_f32_bf16 v50, v159, v159, v50
    s_nop 2
    v_add_f32 v49, v49, v50
    v_mov_b32 v48, v52
    s_cmp_lg_u32 s64, 0
    s_cbranch_scc1 L_nofin
    s_lshl_b32 s77, s62, 12
    s_lshr_b32 s76, s63, 2
    s_lshl_b32 s76, s76, 11
    s_add_u32 s77, s77, s76
    s_bfe_u32 s76, s63, 0x10001
    s_lshl_b32 s76, s76, 9
    s_add_u32 s77, s77, s76
    s_and_b32 s76, s63, 1
    s_lshl_b32 s76, s76, 10
    s_add_u32 s77, s77, s76
    s_add_u32 s77, s77, 131072
    s_barrier
    ds_read_b64 v[64:65], v235 offset:512
    ds_read_b128 v[56:59], v234 offset:4096
    ds_read_b128 v[60:63], v234 offset:5120
    ds_read_b64 v[74:75], v235 offset:1024
    ds_read_b128 v[66:69], v234 offset:8192
    ds_read_b128 v[70:73], v234 offset:9216
    ds_read_b64 v[84:85], v235 offset:1536
    ds_read_b128 v[76:79], v234 offset:12288
    ds_read_b128 v[80:83], v234 offset:13312
    s_waitcnt lgkmcnt(6)
    v_pk_add_f32 v[48:49], v[48:49], v[64:65]
    v_pk_add_f32 v[40:41], v[40:41], v[56:57]
    v_pk_add_f32 v[42:43], v[42:43], v[58:59]
    v_pk_add_f32 v[44:45], v[44:45], v[60:61]
    v_pk_add_f32 v[46:47], v[46:47], v[62:63]
    s_waitcnt lgkmcnt(3)
    v_pk_add_f32 v[48:49], v[48:49], v[74:75]
    v_pk_add_f32 v[40:41], v[40:41], v[66:67]
    v_pk_add_f32 v[42:43], v[42:43], v[68:69]
    v_pk_add_f32 v[44:45], v[44:45], v[70:71]
    v_pk_add_f32 v[46:47], v[46:47], v[72:73]
    s_waitcnt lgkmcnt(0)
    v_pk_add_f32 v[48:49], v[48:49], v[84:85]
    v_pk_add_f32 v[40:41], v[40:41], v[76:77]
    v_pk_add_f32 v[42:43], v[42:43], v[78:79]
    v_pk_add_f32 v[44:45], v[44:45], v[80:81]
    v_pk_add_f32 v[46:47], v[46:47], v[82:83]
    v_mov_b32 v10, v49
    v_mul_f32 v11, 0xbb000000, v48
    s_nop 0
    v_permlane32_swap_b32 v10, v49
    v_add_f32 v49, v49, v10
    v_mov_b32 v10, v49
    v_fma_f32 v40, v11, v44, v40
    v_fma_f32 v41, v11, v45, v41
    v_permlane16_swap_b32 v10, v49
    v_add_f32 v49, v49, v10
    v_mul_f32 v49, 0x3b000000, v49
    v_fma_f32 v49, -v11, v11, v49
    v_max_f32 v49, 0, v49
    v_add_f32 v49, 0x3727c5ac, v49
    v_rsq_f32 v49, v49
    v_fma_f32 v42, v11, v46, v42
    v_fma_f32 v43, v11, v47, v43
    v_mul_f32 v40, v49, v40
    v_mul_f32 v41, v49, v41
    v_mul_f32 v42, v49, v42
    v_mul_f32 v43, v49, v43
    v_cvt_pk_bf16_f32 v40, v40, v41
    v_cvt_pk_bf16_f32 v42, v42, v43
    ds_write_b16 v228, v40
    ds_write_b16_d16_hi v229, v40
    ds_write_b16 v230, v42
    ds_write_b16_d16_hi v231, v42
    s_mov_b64 exec, 0xffffffff
    ds_read_b128 v[24:27], v236 offset:0
    s_waitcnt lgkmcnt(0)
    buffer_store_dwordx4 v[24:27], v1, s[36:39], s77 offen sc1
    v_cvt_pk_bf16_f32 v48, v11, v11
    v_lshlrev_b32 v48, 16, v48
    v_sub_f32 v10, v11, v48
    v_cvt_pk_bf16_f32 v48, v48, v10
    v_mul_f32 v49, 0x3eb8aa3b, v49
    s_mov_b64 exec, 0xffff
    ds_write_b64 v232, v[48:49] offset:1024
    s_mov_b64 exec, -1
    s_branch L_fin
L_nofin:
    ds_write_b64 v235, v[48:49]
    ds_write_b128 v234, v[40:43] offset:0
    ds_write_b128 v234, v[44:47] offset:1024
    s_waitcnt lgkmcnt(0)
    s_barrier
L_xrest:
    s_mul_i32 m0, s81, 1040
    s_lshl_b32 s77, s81, 10
    s_add_u32 s77, s77, s78
    buffer_load_dwordx4 v1, s[8:11], s77 offen lds
    s_add_u32 m0, m0, 1040
    s_add_u32 s77, s77, 1024
    buffer_load_dwordx4 v1, s[8:11], s77 offen lds
    s_add_u32 m0, m0, 1040
    s_add_u32 s77, s77, 1024
    buffer_load_dwordx4 v1, s[8:11], s77 offen lds
    s_add_u32 m0, m0, 1040
    s_add_u32 s77, s77, 1024
    buffer_load_dwordx4 v1, s[8:11], s77 offen lds
    s_add_u32 m0, m0, 1040
    s_add_u32 s77, s77, 1024
    buffer_load_dwordx4 v1, s[8:11], s77 offen lds
    s_add_u32 m0, m0, 1040
    s_add_u32 s77, s77, 1024
    buffer_load_dwordx4 v1, s[8:11], s77 offen lds
    s_add_u32 m0, m0, 1040
    s_add_u32 s77, s77, 1024
    buffer_load_dwordx4 v1, s[8:11], s77 offen lds
    s_add_u32 m0, m0, 1040
    s_add_u32 s77, s77, 1024
    buffer_load_dwordx4 v1, s[8:11], s77 offen lds
    v_mov_b64 v[16:17], 0
    v_mov_b64 v[28:29], 0
    v_mov_b64 v[30:31], 0
    v_mov_b32 v6, 0xdddddddd
    v_and_b32 v10, 0xf0, v1
    v_lshrrev_b32 v11, 5, v0
    v_lshl_add_u32 v5, v11, 8, v10
    v_bfe_u32 v12, v0, 4, 1
    v_lshl_add_u32 v4, v12, 9, v5
    v_bfe_u32 v10, v0, 2, 2
    v_and_b32 v15, 2, v10
    v_xor_b32 v12, v12, v15
    v_and_b32 v14, 3, v0
    v_lshlrev_b32 v14, 3, v14
    v_lshl_add_u32 v14, v10, 7, v14
    v_xor_b32 v13, s68, v12
    v_lshl_add_u32 v13, v13, 5, v14
    v_lshl_add_u32 v13, v11, 9, v13
    v_add_u32 v8, s85, v13
    v_xor_b32 v9, 64, v8
    s_lshl_b32 s77, s66, 1
    s_or_b32 s77, s77, s67
    s_lshl_b32 s76, s67, 15
    s_add_u32 s76, s76, 66560
    v_xor_b32 v13, s77, v12
    v_lshl_add_u32 v13, v13, 5, v14
    v_lshl_add_u32 v13, v11, 10, v13
    v_add_u32 v239, s76, v13
    v_and_b32 v10, 31, v0
    s_lshl_b32 s76, s65, 5
    v_add_u32 v10, s76, v10
    v_mul_u32_u24 v12, 1040, v10
    v_add_u32 v242, 1024, v12
    s_lshl_b32 s76, s67, 9
    v_lshl_add_u32 v240, v11, 4, v12
    v_add_u32 v240, s76, v240
    s_lshl_b32 s76, s63, 7
    s_lshl_b32 s77, s68, 5
    s_add_u32 s76, s76, s77
    v_lshl_add_u32 v241, v11, 3, v12
    v_add_u32 v241, s76, v241
    v_bfe_u32 v11, v0, 2, 3
    v_add_u32 v11, s81, v11
    v_mul_u32_u24 v238, 1040, v11
    v_and_b32 v12, 7, v0
    v_and_b32 v13, 3, v0
    v_lshl_add_u32 v237, v13, 4, v238
    v_lshrrev_b32 v11, 5, v0
    v_lshl_add_u32 v237, v11, 6, v237
    s_xor_b32 s76, s85, 0x8000
    v_add_u32 v243, s76, v1
    v_add_u32 v244, s85, v1
    s_lshl_b32 s76, s64, 5
    v_add_u32 v11, s76, v0
    s_lshl_b32 s76, s62, 3
    v_add_u32 v13, s76, v12
    v_cmp_gt_u32 vcc, 32, v0
    s_nop 1
    v_cndmask_b32 v11, v13, v11, vcc
    v_lshlrev_b32 v245, 4, v11
    v_bfe_u32 v10, v0, 2, 1
    v_mul_lo_u32 v194, v10, s71
    v_sub_u32 v192, s71, v194
    v_mov_b32 v193, v192
    v_mov_b32 v195, v194
    v_bfe_u32 v10, v0, 3, 1
    v_mul_u32_u24 v10, 0xaaaa, v10
    v_add_u32 v200, 0x4444, v10
    v_mov_b64 v[196:197], 0
    v_mov_b64 v[198:199], 0
    s_lshl_b32 s84, s64, 16
    s_lshl_b32 s77, s63, 7
    s_add_u32 s84, s84, s77
    s_cmp_eq_u32 s64, 7
    s_cselect_b32 s82, 0, s64
    s_cselect_b32 s83, 196608, 0
    s_add_u32 s77, s77, s83
    s_add_u32 s82, s82, s63
    s_add_u32 s82, s82, 1
    s_and_b32 s82, s82, 7
    s_mul_i32 s82, s82, 229376
    s_add_u32 s82, s82, s77
    s_mul_i32 s83, s63, 448
    v_mov_b64 v[56:57], 0
    v_mov_b64 v[72:73], 0
    v_mov_b64 v[58:59], 0
    v_mov_b64 v[74:75], 0
    v_mov_b64 v[60:61], 0
    v_mov_b64 v[76:77], 0
    v_mov_b64 v[62:63], 0
    v_mov_b64 v[78:79], 0
    v_mov_b64 v[64:65], 0
    v_mov_b64 v[80:81], 0
    v_mov_b64 v[92:93], s[92:93]
    v_mov_b64 v[94:95], s[92:93]
    v_mov_b64 v[96:97], s[92:93]
    v_mov_b64 v[98:99], s[92:93]
    v_mov_b64 v[104:105], s[92:93]
    v_mov_b64 v[106:107], s[92:93]
    v_mov_b64 v[108:109], s[92:93]
    v_mov_b64 v[110:111], s[92:93]
    v_mov_b64 v[116:117], s[92:93]
    v_mov_b64 v[118:119], s[92:93]
    v_mov_b64 v[120:121], s[92:93]
    v_mov_b64 v[122:123], s[92:93]
    v_mov_b64 v[128:129], s[92:93]
    v_mov_b64 v[130:131], s[92:93]
    v_mov_b64 v[132:133], s[92:93]
    v_mov_b64 v[134:135], s[92:93]
    s_waitcnt vmcnt(0)
    ds_read_b128 v[144:147], v237 offset:0
    ds_read_b128 v[148:151], v237 offset:128
    ds_read_b128 v[152:155], v237 offset:256
    ds_read_b128 v[156:159], v237 offset:384
    ds_read_b128 v[160:163], v237 offset:512
    ds_read_b128 v[164:167], v237 offset:640
    ds_read_b128 v[168:171], v237 offset:768
    ds_read_b128 v[172:175], v237 offset:896
    s_waitcnt lgkmcnt(7)
    v_dot2_f32_bf16 v16, v144, v144, v16
    v_dot2_f32_bf16 v17, v145, v145, v17
    v_dot2_f32_bf16 v16, v146, v146, v16
    v_dot2_f32_bf16 v17, v147, v147, v17
    s_waitcnt lgkmcnt(6)
    v_dot2_f32_bf16 v16, v148, v148, v16
    v_dot2_f32_bf16 v17, v149, v149, v17
    v_dot2_f32_bf16 v16, v150, v150, v16
    v_dot2_f32_bf16 v17, v151, v151, v17
    v_smfmac_f32_16x16x64_bf16 v[28:31], v[192:195], v[144:151], v200
    s_waitcnt lgkmcnt(5)
    v_dot2_f32_bf16 v16, v152, v152, v16
    v_dot2_f32_bf16 v17, v153, v153, v17
    v_dot2_f32_bf16 v16, v154, v154, v16
    v_dot2_f32_bf16 v17, v155, v155, v17
    s_waitcnt lgkmcnt(4)
    v_dot2_f32_bf16 v16, v156, v156, v16
    v_dot2_f32_bf16 v17, v157, v157, v17
    v_dot2_f32_bf16 v16, v158, v158, v16
    v_dot2_f32_bf16 v17, v159, v159, v17
    v_smfmac_f32_16x16x64_bf16 v[28:31], v[192:195], v[152:159], v200
    s_waitcnt lgkmcnt(3)
    v_dot2_f32_bf16 v16, v160, v160, v16
    v_dot2_f32_bf16 v17, v161, v161, v17
    v_dot2_f32_bf16 v16, v162, v162, v16
    v_dot2_f32_bf16 v17, v163, v163, v17
    s_waitcnt lgkmcnt(2)
    v_dot2_f32_bf16 v16, v164, v164, v16
    v_dot2_f32_bf16 v17, v165, v165, v17
    v_dot2_f32_bf16 v16, v166, v166, v16
    v_dot2_f32_bf16 v17, v167, v167, v17
    v_smfmac_f32_16x16x64_bf16 v[28:31], v[192:195], v[160:167], v200
    s_waitcnt lgkmcnt(1)
    v_dot2_f32_bf16 v16, v168, v168, v16
    v_dot2_f32_bf16 v17, v169, v169, v17
    v_dot2_f32_bf16 v16, v170, v170, v16
    v_dot2_f32_bf16 v17, v171, v171, v17
    s_waitcnt lgkmcnt(0)
    v_dot2_f32_bf16 v16, v172, v172, v16
    v_dot2_f32_bf16 v17, v173, v173, v17
    v_dot2_f32_bf16 v16, v174, v174, v16
    v_dot2_f32_bf16 v17, v175, v175, v17
    v_smfmac_f32_16x16x64_bf16 v[28:31], v[192:195], v[168:175], v200
    s_nop 1
    v_add_f32 v19, v16, v17
    v_mov_b32 v16, v19
    s_nop 3
    v_mov_b32 v18, v28
    v_permlane32_swap_b32 v16, v19
    s_nop 0
    v_permlane32_swap_b32 v28, v18
    v_add_f32 v19, v16, v19
    v_add_f32 v18, v28, v18
    s_nop 0
    v_add_f32_dpp v19, v19, v19 quad_perm:[1,0,3,2] row_mask:0xf bank_mask:0xf
    v_add_f32_dpp v18, v18, v18 quad_perm:[1,0,3,2] row_mask:0xf bank_mask:0xf
    s_nop 0
    v_add_f32_dpp v19, v19, v19 quad_perm:[2,3,0,1] row_mask:0xf bank_mask:0xf
    v_add_f32_dpp v18, v18, v18 quad_perm:[2,3,0,1] row_mask:0xf bank_mask:0xf
    v_mul_f32 v11, 0xbb000000, v18
    v_mul_f32 v19, 0x3b000000, v19
    v_fma_f32 v19, -v11, v11, v19
    v_max_f32 v19, 0, v19
    v_add_f32 v19, 0x3727c5ac, v19
    v_rsq_f32 v19, v19
    v_cvt_pk_bf16_f32 v18, v11, v11
    v_lshlrev_b32 v18, 16, v18
    v_sub_f32 v10, v11, v18
    v_cvt_pk_bf16_f32 v18, v18, v10
    v_mul_f32 v19, 0x3eb8aa3b, v19
    ds_write_b64 v238, v[18:19] offset:1024
    s_branch L_fin2
L_fin:
    v_mov_b32 v6, 0xdddddddd
    v_and_b32 v10, 0xf0, v1
    v_lshrrev_b32 v11, 5, v0
    v_lshl_add_u32 v5, v11, 8, v10
    v_bfe_u32 v12, v0, 4, 1
    v_lshl_add_u32 v4, v12, 9, v5
    v_bfe_u32 v10, v0, 2, 2
    v_and_b32 v15, 2, v10
    v_xor_b32 v12, v12, v15
    v_and_b32 v14, 3, v0
    v_lshlrev_b32 v14, 3, v14
    v_lshl_add_u32 v14, v10, 7, v14
    v_xor_b32 v13, s68, v12
    v_lshl_add_u32 v13, v13, 5, v14
    v_lshl_add_u32 v13, v11, 9, v13
    v_add_u32 v8, s85, v13
    v_xor_b32 v9, 64, v8
    s_lshl_b32 s77, s66, 1
    s_or_b32 s77, s77, s67
    s_lshl_b32 s76, s67, 15
    s_add_u32 s76, s76, 66560
    v_xor_b32 v13, s77, v12
    v_lshl_add_u32 v13, v13, 5, v14
    v_lshl_add_u32 v13, v11, 10, v13
    v_add_u32 v239, s76, v13
    v_and_b32 v10, 31, v0
    s_lshl_b32 s76, s65, 5
    v_add_u32 v10, s76, v10
    v_mul_u32_u24 v12, 1040, v10
    v_add_u32 v242, 1024, v12
    s_lshl_b32 s76, s67, 9
    v_lshl_add_u32 v240, v11, 4, v12
    v_add_u32 v240, s76, v240
    s_lshl_b32 s76, s63, 7
    s_lshl_b32 s77, s68, 5
    s_add_u32 s76, s76, s77
    v_lshl_add_u32 v241, v11, 3, v12
    v_add_u32 v241, s76, v241
    v_bfe_u32 v11, v0, 2, 3
    v_add_u32 v11, s81, v11
    v_mul_u32_u24 v238, 1040, v11
    v_and_b32 v12, 7, v0
    v_and_b32 v13, 3, v0
    v_lshl_add_u32 v237, v13, 4, v238
    v_lshrrev_b32 v11, 5, v0
    v_lshl_add_u32 v237, v11, 6, v237
    s_xor_b32 s76, s85, 0x8000
    v_add_u32 v243, s76, v1
    v_add_u32 v244, s85, v1
    s_lshl_b32 s76, s64, 5
    v_add_u32 v11, s76, v0
    s_lshl_b32 s76, s62, 3
    v_add_u32 v13, s76, v12
    v_cmp_gt_u32 vcc, 32, v0
    s_nop 1
    v_cndmask_b32 v11, v13, v11, vcc
    v_lshlrev_b32 v245, 4, v11
    v_bfe_u32 v10, v0, 2, 1
    v_mul_lo_u32 v194, v10, s71
    v_sub_u32 v192, s71, v194
    v_mov_b32 v193, v192
    v_mov_b32 v195, v194
    v_bfe_u32 v10, v0, 3, 1
    v_mul_u32_u24 v10, 0xaaaa, v10
    v_add_u32 v200, 0x4444, v10
    v_mov_b64 v[196:197], 0
    v_mov_b64 v[198:199], 0
    s_lshl_b32 s84, s64, 16
    s_lshl_b32 s77, s63, 7
    s_add_u32 s84, s84, s77
    s_cmp_eq_u32 s64, 7
    s_cselect_b32 s82, 0, s64
    s_cselect_b32 s83, 196608, 0
    s_add_u32 s77, s77, s83
    s_add_u32 s82, s82, s63
    s_add_u32 s82, s82, 1
    s_and_b32 s82, s82, 7
    s_mul_i32 s82, s82, 229376
    s_add_u32 s82, s82, s77
    s_mul_i32 s83, s63, 448
    v_mov_b64 v[56:57], 0
    v_mov_b64 v[72:73], 0
    v_mov_b64 v[58:59], 0
    v_mov_b64 v[74:75], 0
    v_mov_b64 v[60:61], 0
    v_mov_b64 v[76:77], 0
    v_mov_b64 v[62:63], 0
    v_mov_b64 v[78:79], 0
    v_mov_b64 v[64:65], 0
    v_mov_b64 v[80:81], 0
    v_mov_b64 v[92:93], s[92:93]
    v_mov_b64 v[94:95], s[92:93]
    v_mov_b64 v[96:97], s[92:93]
    v_mov_b64 v[98:99], s[92:93]
    v_mov_b64 v[104:105], s[92:93]
    v_mov_b64 v[106:107], s[92:93]
    v_mov_b64 v[108:109], s[92:93]
    v_mov_b64 v[110:111], s[92:93]
    v_mov_b64 v[116:117], s[92:93]
    v_mov_b64 v[118:119], s[92:93]
    v_mov_b64 v[120:121], s[92:93]
    v_mov_b64 v[122:123], s[92:93]
    v_mov_b64 v[128:129], s[92:93]
    v_mov_b64 v[130:131], s[92:93]
    v_mov_b64 v[132:133], s[92:93]
    v_mov_b64 v[134:135], s[92:93]
L_fin2:
    s_waitcnt lgkmcnt(0)
    s_mul_i32 s69, s86, 0x9e3779b1
    s_add_u32 s69, s69, 0x7f4a7c15
    s_getreg_b32 s73, hwreg(HW_REG_XCC_ID)
    s_and_b32 s73, s73, 15
    v_mov_b32 v7, s69
    s_lshl_b32 s75, s62, 3
    s_add_u32 s75, s75, s63
    s_lshl_b32 s75, s75, 4
    s_add_u32 s75, s75, 4096
    v_mov_b32 v14, s69
    v_mov_b32 v15, s73
    s_waitcnt vmcnt(0)
    s_waitcnt vmcnt(0)
    s_cmp_lg_u32 s64, 0
    s_cbranch_scc1 L_w0
    s_waitcnt vmcnt(0)
    s_mov_b64 exec, 1
    buffer_store_dwordx2 v[14:15], off, s[36:39], s75 sc1
    s_mov_b64 exec, -1
L_w0:
    s_barrier
    ds_read_b64_tr_b16 v[144:145], v239 offset:0
    ds_read_b64_tr_b16 v[146:147], v239 offset:512
    ds_read_b128 v[168:171], v240 offset:0
    ds_read_b64_tr_b16 v[148:149], v239 offset:2048
    ds_read_b64_tr_b16 v[150:151], v239 offset:2560
    ds_read_b128 v[172:175], v240 offset:32
    ds_read_b64_tr_b16 v[152:153], v239 offset:4096
    ds_read_b64_tr_b16 v[154:155], v239 offset:4608
    ds_read_b128 v[176:179], v240 offset:64
    ds_read_b64_tr_b16 v[156:157], v239 offset:6144
    ds_read_b64_tr_b16 v[158:159], v239 offset:6656
    ds_read_b128 v[180:183], v240 offset:96
    s_waitcnt lgkmcnt(9)
    v_mfma_f32_32x32x16_bf16 v[24:39], v[144:147], v[168:171], 0
    ds_read_b64_tr_b16 v[160:161], v239 offset:8192
    ds_read_b64_tr_b16 v[162:163], v239 offset:8704
    ds_read_b128 v[184:187], v240 offset:128
    s_lshl_b32 s76, s2, 3
    s_add_u32 s76, s76, s64
    s_mul_i32 s77, s76, 896
    s_lshl_b32 s76, s76, 8
    v_lshlrev_b32 v10, 7, v0
    v_and_b32 v11, 128, v10
    s_mov_b64 exec, 0x7f
    buffer_load_dword v143, v10, s[28:31], s77 offen
    buffer_load_dword v142, v10, s[24:27], s77 offen
    buffer_load_dword v22, v11, s[20:23], s76 offen
    s_mov_b64 exec, -1
    s_waitcnt lgkmcnt(9)
    v_mfma_f32_32x32x16_bf16 v[24:39], v[148:151], v[172:175], v[24:39]
    v_smfmac_f32_16x16x64_bf16 v[196:199], v[192:195], v[144:151], v200
    ds_read_b64_tr_b16 v[164:165], v239 offset:10240
    ds_read_b64_tr_b16 v[166:167], v239 offset:10752
    ds_read_b128 v[188:191], v240 offset:160
    s_mov_b32 s88, 0xffff
    s_mov_b32 s89, 0xffff
    s_cmp_lt_u32 s64, 7
    s_cselect_b64 s[90:91], -1, 0
    s_lshl_b32 s77, s64, 6
    v_add_u32 v13, s77, v0
    v_mul_u32_u24 v12, 2341, v13
    v_lshrrev_b32 v12, 16, v12
    s_waitcnt lgkmcnt(9)
    v_mfma_f32_32x32x16_bf16 v[24:39], v[152:155], v[176:179], v[24:39]
    ds_read_b64_tr_b16 v[144:145], v239 offset:12288
    ds_read_b64_tr_b16 v[146:147], v239 offset:12800
    ds_read_b128 v[168:171], v240 offset:192
    v_mul_u32_u24 v12, 3136, v12
    v_lshl_add_u32 v3, v13, 4, v12
    s_lshl_b32 s87, s62, 3
    s_add_u32 s87, s87, s63
    s_lshl_b32 s87, s87, 5
    s_add_u32 s87, s87, s64
    s_lshl_b32 s87, s87, 2
    s_add_u32 s87, s87, 8192
    s_waitcnt lgkmcnt(9)
    v_mfma_f32_32x32x16_bf16 v[24:39], v[156:159], v[180:183], v[24:39]
    v_smfmac_f32_16x16x64_bf16 v[196:199], v[192:195], v[152:159], v200
    ds_read_b64_tr_b16 v[148:149], v239 offset:14336
    ds_read_b64_tr_b16 v[150:151], v239 offset:14848
    ds_read_b128 v[172:175], v240 offset:224
    s_mul_i32 s3, s62, 229376
    s_add_u32 s3, s3, 4456448
    s_lshl_b32 s77, s65, 15
    s_add_u32 s3, s3, s77
    s_lshl_b32 s80, s62, 16
    s_add_u32 s80, s80, s77
    s_waitcnt lgkmcnt(9)
    v_mfma_f32_32x32x16_bf16 v[24:39], v[160:163], v[184:187], v[24:39]
    ds_read_b64_tr_b16 v[152:153], v239 offset:16384
    ds_read_b64_tr_b16 v[154:155], v239 offset:16896
    ds_read_b128 v[176:179], v240 offset:256
    s_lshl_b32 s76, s63, 2
    s_add_u32 s77, s76, s68
    s_lshl_b32 s77, s77, 10
    s_add_u32 s40, s77, s80
    s_add_u32 s40, s40, 0
    s_lshl_b32 s77, s66, 1
    s_add_u32 s77, s77, s67
    s_add_u32 s76, s76, s77
    s_lshl_b32 s76, s76, 10
    s_add_u32 s41, s76, s3
    s_waitcnt lgkmcnt(9)
    v_mfma_f32_32x32x16_bf16 v[24:39], v[164:167], v[188:191], v[24:39]
    v_smfmac_f32_16x16x64_bf16 v[196:199], v[192:195], v[160:167], v200
    ds_read_b64_tr_b16 v[156:157], v239 offset:18432
    ds_read_b64_tr_b16 v[158:159], v239 offset:18944
    ds_read_b128 v[180:183], v240 offset:288
    s_lshr_b32 s76, s2, 6
    s_lshl_b32 s76, s76, 3
    s_add_u32 s76, s76, s64
    s_mul_i32 s76, s76, 11
    s_add_u32 s76, s76, 160
    s_mul_i32 s76, s76, 3584
    s_and_b32 s77, s83, 0xffffff80
    s_add_u32 s76, s76, s77
    s_waitcnt lgkmcnt(9)
    v_mfma_f32_32x32x16_bf16 v[24:39], v[144:147], v[168:171], v[24:39]
    ds_read_b64_tr_b16 v[160:161], v239 offset:20480
    ds_read_b64_tr_b16 v[162:163], v239 offset:20992
    ds_read_b128 v[184:187], v240 offset:320
    v_lshrrev_b32 v141, 2, v0
    v_min_u32 v141, 10, v141
    v_mul_u32_u24 v141, 3584, v141
    v_and_b32 v12, 3, v0
    v_lshl_add_u32 v141, v12, 7, v141
    v_add_u32 v141, s76, v141
    s_waitcnt lgkmcnt(9)
    v_mfma_f32_32x32x16_bf16 v[24:39], v[148:151], v[172:175], v[24:39]
    v_smfmac_f32_16x16x64_bf16 v[196:199], v[192:195], v[144:151], v200
    ds_read_b64_tr_b16 v[164:165], v239 offset:22528
    ds_read_b64_tr_b16 v[166:167], v239 offset:23040
    ds_read_b128 v[188:191], v240 offset:352
    v_min_u32 v12, 2, v12
    v_lshlrev_b32 v12, 15, v12
    v_add_u32 v140, s87, v12
    v_and_b32 v12, 7, v0
    v_lshlrev_b32 v12, 7, v12
    v_add_u32 v13, s40, v12
    s_waitcnt lgkmcnt(9)
    v_mfma_f32_32x32x16_bf16 v[24:39], v[152:155], v[176:179], v[24:39]
    ds_read_b64_tr_b16 v[144:145], v239 offset:24576
    ds_read_b64_tr_b16 v[146:147], v239 offset:25088
    ds_read_b128 v[168:171], v240 offset:384
    v_cmp_gt_u32 vcc, 16, v0
    v_add_u32 v12, s41, v12
    s_nop 0
    v_cndmask_b32 v140, v140, v13, vcc
    v_cmp_gt_u32 vcc, 8, v0
    s_lshl_b32 s81, s67, 16
    s_add_u32 s81, s81, 131072
    v_cndmask_b32 v140, v140, v12, vcc
    s_waitcnt lgkmcnt(9)
    v_mfma_f32_32x32x16_bf16 v[24:39], v[156:159], v[180:183], v[24:39]
    v_smfmac_f32_16x16x64_bf16 v[196:199], v[192:195], v[152:159], v200
    ds_read_b64_tr_b16 v[148:149], v239 offset:26624
    ds_read_b64_tr_b16 v[150:151], v239 offset:27136
    ds_read_b128 v[172:175], v240 offset:416
    ds_read_b64 v[246:247], v242
    ds_read_b64 v[136:137], v241
    ds_read_b64 v[138:139], v241 offset:16
    v_mov_b64 v[206:207], 0
    v_mov_b64 v[210:211], 0
    s_waitcnt lgkmcnt(12)
    v_mfma_f32_32x32x16_bf16 v[24:39], v[160:163], v[184:187], v[24:39]
    ds_read_b64_tr_b16 v[152:153], v239 offset:28672
    ds_read_b64_tr_b16 v[154:155], v239 offset:29184
    ds_read_b128 v[176:179], v240 offset:448
    s_waitcnt lgkmcnt(12)
    v_mfma_f32_32x32x16_bf16 v[24:39], v[164:167], v[188:191], v[24:39]
    v_smfmac_f32_16x16x64_bf16 v[196:199], v[192:195], v[160:167], v200
    ds_read_b64_tr_b16 v[156:157], v239 offset:30720
    ds_read_b64_tr_b16 v[158:159], v239 offset:31232
    ds_read_b128 v[180:183], v240 offset:480
    s_waitcnt lgkmcnt(12)
    v_mfma_f32_32x32x16_bf16 v[24:39], v[144:147], v[168:171], v[24:39]
    s_mov_b32 s74, 4096
    buffer_load_dwordx2 v[14:15], v245, s[36:39], s74 offen sc1
    s_waitcnt lgkmcnt(9)
    v_mfma_f32_32x32x16_bf16 v[24:39], v[148:151], v[172:175], v[24:39]
    v_smfmac_f32_16x16x64_bf16 v[196:199], v[192:195], v[144:151], v200
    s_waitcnt lgkmcnt(1)
    v_smfmac_f32_16x16x64_bf16 v[196:199], v[192:195], v[152:159], v200
    v_mfma_f32_32x32x16_bf16 v[24:39], v[152:155], v[176:179], v[24:39]
    v_mov_b32 v208, v246
    v_mov_b32 v209, v246
    s_nop 4
    v_cvt_pk_bf16_f32 v204, v196, v196
    v_lshlrev_b32 v197, 16, v204
    v_sub_f32 v196, v196, v197
    v_cvt_pk_bf16_f32 v205, v196, v196
    s_waitcnt lgkmcnt(0)
    v_mfma_f32_32x32x16_bf16 v[24:39], v[156:159], v[180:183], v[24:39]
    v_mfma_f32_32x32x16_bf16 v[24:39], v[204:207], v[208:211], v[24:39]
    s_mov_b32 s76, 4096
    s_barrier
    s_nop 9
    ds_write_b128 v243, v[24:27] offset:0
    ds_write_b128 v243, v[28:31] offset:1024
    ds_write_b128 v243, v[32:35] offset:2048
    ds_write_b128 v243, v[36:39] offset:3072
    s_waitcnt vmcnt(0)
    v_cmp_ne_u32 vcc, s69, v14
    s_nop 0
    s_cbranch_vccz L_seen_2
    s_mov_b32 s74, 65536
L_poll_1:
    buffer_load_dwordx2 v[14:15], v245, s[36:39], s76 offen sc1
    s_waitcnt vmcnt(0)
    v_cmp_ne_u32 vcc, s69, v14
    s_nop 0
    s_cbranch_vccz L_seen_2
    s_sub_u32 s74, s74, 1
    s_cbranch_scc0 L_poll_1
L_seen_2:
    v_cmp_ne_u32 vcc, s73, v15
    s_nop 1
    s_cmp_eq_u32 vcc_hi, 0
    s_cselect_b32 s70, 1, 0
    s_waitcnt lgkmcnt(0)
    s_barrier
    s_mov_b32 s74, s81
    buffer_load_dwordx4 v[88:91], v4, s[36:39], s74 offen offset:0
    s_mov_b64 exec, s[88:89]
    buffer_load_dwordx4 v[92:95], v5, s[36:39], s81 offen offset:1024
    buffer_load_dwordx4 v[96:99], v5, s[36:39], s81 offen offset:1536
    s_mov_b64 exec, -1
    ds_read_b128 v[40:43], v244 offset:0
    ds_read_b128 v[44:47], v244 offset:1024
    ds_read_b128 v[48:51], v244 offset:2048
    ds_read_b128 v[52:55], v244 offset:3072
    buffer_load_dwordx4 v[100:103], v4, s[36:39], s74 offen offset:2048
    s_add_u32 s74, s74, 4096
    s_mov_b64 exec, s[88:89]
    buffer_load_dwordx4 v[104:107], v5, s[36:39], s81 offen offset:3072
    buffer_load_dwordx4 v[108:111], v5, s[36:39], s81 offen offset:3584
    s_mov_b64 exec, -1
    s_add_u32 s81, s81, 4096
    buffer_load_dwordx4 v[112:115], v4, s[36:39], s74 offen offset:0
    s_mov_b64 exec, s[88:89]
    buffer_load_dwordx4 v[116:119], v5, s[36:39], s81 offen offset:1024
    buffer_load_dwordx4 v[120:123], v5, s[36:39], s81 offen offset:1536
    s_mov_b64 exec, -1
    v_mul_lo_u32 v140, v140, s70
    v_mov_b32 v246, v247
    s_waitcnt lgkmcnt(0)
    v_pk_add_f32 v[24:25], v[24:25], v[48:49]
    v_pk_add_f32 v[26:27], v[26:27], v[50:51]
    v_pk_add_f32 v[28:29], v[28:29], v[52:53]
    v_pk_add_f32 v[30:31], v[30:31], v[54:55]
    v_pk_add_f32 v[32:33], v[32:33], v[40:41]
    v_pk_add_f32 v[34:35], v[34:35], v[42:43]
    v_pk_add_f32 v[36:37], v[36:37], v[44:45]
    v_pk_add_f32 v[38:39], v[38:39], v[46:47]
    v_pk_mul_f32 v[24:25], v[24:25], v[246:247]
    v_pk_mul_f32 v[26:27], v[26:27], v[246:247]
    v_pk_mul_f32 v[28:29], v[28:29], v[246:247]
    v_pk_mul_f32 v[30:31], v[30:31], v[246:247]
    v_pk_mul_f32 v[32:33], v[32:33], v[246:247]
    v_pk_mul_f32 v[34:35], v[34:35], v[246:247]
    v_pk_mul_f32 v[36:37], v[36:37], v[246:247]
    v_pk_mul_f32 v[38:39], v[38:39], v[246:247]
    v_cvt_pk_bf16_f32 v16, v24, v25
    v_cvt_pk_bf16_f32 v17, v26, v27
    v_cvt_pk_bf16_f32 v18, v28, v29
    v_cvt_pk_bf16_f32 v19, v30, v31
    v_cvt_pk_bf16_f32 v20, v32, v33
    v_cvt_pk_bf16_f32 v21, v34, v35
    v_cvt_pk_bf16_f32 v22, v36, v37
    v_cvt_pk_bf16_f32 v23, v38, v39
    s_lshl_b32 s79, s64, 10
    s_mov_b32 s86, 32768
    s_cmp_eq_u32 s64, 7
    s_cselect_b32 s86, 229376, s86
    s_waitcnt vmcnt(8)
    v_mfma_f32_32x32x16_bf16 v[24:39], v[88:91], v[16:19], 0
    s_setprio 3
    s_nop 10
    v_exp_f32 v24, v24
    v_exp_f32 v25, v25
    buffer_load_dwordx4 v[124:127], v4, s[36:39], s74 offen offset:2048
    s_add_u32 s74, s74, 4096
    s_mov_b64 exec, s[88:89]
    buffer_load_dwordx4 v[128:131], v5, s[36:39], s81 offen offset:3072
    buffer_load_dwordx4 v[132:135], v5, s[36:39], s81 offen offset:3584
    s_mov_b64 exec, -1
    s_add_u32 s81, s81, 4096
    v_exp_f32 v26, v26
    v_exp_f32 v27, v27
    v_exp_f32 v28, v28
    v_mfma_f32_32x32x16_bf16 v[40:55], v[88:91], v[20:23], 0
    v_exp_f32 v29, v29
    v_exp_f32 v30, v30
    v_exp_f32 v31, v31
    v_exp_f32 v32, v32
    v_exp_f32 v33, v33
    s_waitcnt vmcnt(9)
    v_smfmac_f32_32x32x32_bf16 v[56:71], v[92:95], v[24:31], v6
    s_add_u32 m0, s85, 0
    s_add_u32 s77, s82, 0
    buffer_load_dwordx4 v2, s[28:31], s77 offen lds
    v_exp_f32 v34, v34
    v_exp_f32 v35, v35
    v_exp_f32 v36, v36
    v_exp_f32 v37, v37
    v_exp_f32 v38, v38
    v_exp_f32 v39, v39
    v_exp_f32 v40, v40
    v_exp_f32 v41, v41
    v_smfmac_f32_32x32x32_bf16 v[56:71], v[96:99], v[32:39], v6
    v_exp_f32 v42, v42
    v_exp_f32 v43, v43
    v_exp_f32 v44, v44
    s_waitcnt vmcnt(9)
    v_mfma_f32_32x32x16_bf16 v[24:39], v[100:103], v[16:19], 0
    v_exp_f32 v45, v45
    v_exp_f32 v46, v46
    v_exp_f32 v47, v47
    v_exp_f32 v48, v48
    v_exp_f32 v49, v49
    v_smfmac_f32_32x32x32_bf16 v[72:87], v[92:95], v[40:47], v6
    s_add_u32 m0, s85, 1024
    s_add_u32 s77, s82, 8192
    buffer_load_dwordx4 v2, s[28:31], s77 offen lds
    v_exp_f32 v50, v50
    v_exp_f32 v51, v51
    v_exp_f32 v52, v52
    v_exp_f32 v53, v53
    v_exp_f32 v54, v54
    v_exp_f32 v55, v55
    v_exp_f32 v24, v24
    v_exp_f32 v25, v25
    v_smfmac_f32_32x32x32_bf16 v[72:87], v[96:99], v[48:55], v6
    buffer_load_dwordx4 v[88:91], v4, s[36:39], s74 offen offset:0
    s_mov_b64 exec, s[88:89]
    buffer_load_dwordx4 v[92:95], v5, s[36:39], s81 offen offset:1024
    buffer_load_dwordx4 v[96:99], v5, s[36:39], s81 offen offset:1536
    s_mov_b64 exec, -1
    v_exp_f32 v26, v26
    v_exp_f32 v27, v27
    v_exp_f32 v28, v28
    v_mfma_f32_32x32x16_bf16 v[40:55], v[100:103], v[20:23], 0
    v_exp_f32 v29, v29
    v_exp_f32 v30, v30
    v_exp_f32 v31, v31
    v_exp_f32 v32, v32
    v_exp_f32 v33, v33
    s_waitcnt vmcnt(11)
    v_smfmac_f32_32x32x32_bf16 v[56:71], v[104:107], v[24:31], v6
    s_add_u32 m0, s85, 2048
    s_add_u32 s77, s82, 16384
    buffer_load_dwordx4 v2, s[28:31], s77 offen lds
    v_exp_f32 v34, v34
    v_exp_f32 v35, v35
    v_exp_f32 v36, v36
    v_exp_f32 v37, v37
    v_exp_f32 v38, v38
    v_exp_f32 v39, v39
    v_exp_f32 v40, v40
    v_exp_f32 v41, v41
    v_smfmac_f32_32x32x32_bf16 v[56:71], v[108:111], v[32:39], v6
    v_exp_f32 v42, v42
    v_exp_f32 v43, v43
    v_exp_f32 v44, v44
    s_waitcnt vmcnt(11)
    v_mfma_f32_32x32x16_bf16 v[24:39], v[112:115], v[16:19], 0
    v_exp_f32 v45, v45
    v_exp_f32 v46, v46
    v_exp_f32 v47, v47
    v_exp_f32 v48, v48
    v_exp_f32 v49, v49
    v_smfmac_f32_32x32x32_bf16 v[72:87], v[104:107], v[40:47], v6
    s_add_u32 m0, s85, 3072
    s_add_u32 s77, s82, 24576
    buffer_load_dwordx4 v2, s[28:31], s77 offen lds
    v_exp_f32 v50, v50
    v_exp_f32 v51, v51
    v_exp_f32 v52, v52
    v_exp_f32 v53, v53
    v_exp_f32 v54, v54
    v_exp_f32 v55, v55
    v_exp_f32 v24, v24
    v_exp_f32 v25, v25
    v_smfmac_f32_32x32x32_bf16 v[72:87], v[108:111], v[48:55], v6
    buffer_load_dwordx4 v[100:103], v4, s[36:39], s74 offen offset:2048
    s_add_u32 s74, s74, 4096
    s_mov_b64 exec, s[88:89]
    buffer_load_dwordx4 v[104:107], v5, s[36:39], s81 offen offset:3072
    buffer_load_dwordx4 v[108:111], v5, s[36:39], s81 offen offset:3584
    s_mov_b64 exec, -1
    s_add_u32 s81, s81, 4096
    v_exp_f32 v26, v26
    v_exp_f32 v27, v27
    v_exp_f32 v28, v28
    v_mfma_f32_32x32x16_bf16 v[40:55], v[112:115], v[20:23], 0
    v_exp_f32 v29, v29
    v_exp_f32 v30, v30
    v_exp_f32 v31, v31
    v_exp_f32 v32, v32
    v_exp_f32 v33, v33
    s_waitcnt vmcnt(13)
    v_smfmac_f32_32x32x32_bf16 v[56:71], v[116:119], v[24:31], v6
    v_exp_f32 v34, v34
    v_exp_f32 v35, v35
    v_exp_f32 v36, v36
    v_exp_f32 v37, v37
    v_exp_f32 v38, v38
    v_exp_f32 v39, v39
    v_exp_f32 v40, v40
    v_exp_f32 v41, v41
    v_smfmac_f32_32x32x32_bf16 v[56:71], v[120:123], v[32:39], v6
    v_exp_f32 v42, v42
    v_exp_f32 v43, v43
    v_exp_f32 v44, v44
    s_waitcnt vmcnt(12)
    v_mfma_f32_32x32x16_bf16 v[24:39], v[124:127], v[16:19], 0
    v_exp_f32 v45, v45
    v_exp_f32 v46, v46
    v_exp_f32 v47, v47
    v_exp_f32 v48, v48
    v_exp_f32 v49, v49
    v_smfmac_f32_32x32x32_bf16 v[72:87], v[116:119], v[40:47], v6
    v_exp_f32 v50, v50
    v_exp_f32 v51, v51
    v_exp_f32 v52, v52
    v_exp_f32 v53, v53
    v_exp_f32 v54, v54
    v_exp_f32 v55, v55
    v_exp_f32 v24, v24
    v_exp_f32 v25, v25
    v_smfmac_f32_32x32x32_bf16 v[72:87], v[120:123], v[48:55], v6
    buffer_load_dwordx4 v[112:115], v4, s[36:39], s74 offen offset:0
    s_mov_b64 exec, s[88:89]
    buffer_load_dwordx4 v[116:119], v5, s[36:39], s81 offen offset:1024
    buffer_load_dwordx4 v[120:123], v5, s[36:39], s81 offen offset:1536
    s_mov_b64 exec, -1
    v_exp_f32 v26, v26
    v_exp_f32 v27, v27
    v_exp_f32 v28, v28
    v_mfma_f32_32x32x16_bf16 v[40:55], v[124:127], v[20:23], 0
    v_exp_f32 v29, v29
    v_exp_f32 v30, v30
    v_exp_f32 v31, v31
    v_exp_f32 v32, v32
    v_exp_f32 v33, v33
    s_waitcnt vmcnt(13)
    v_smfmac_f32_32x32x32_bf16 v[56:71], v[128:131], v[24:31], v6
    s_add_u32 s82, s82, s86
    s_sub_u32 s77, s82, 1835008
    s_cselect_b32 s82, s82, s77
    s_add_u32 m0, s85, 4096
    s_add_u32 s77, s82, 0
    buffer_load_dwordx4 v2, s[28:31], s77 offen lds
    v_exp_f32 v34, v34
    v_exp_f32 v35, v35
    v_exp_f32 v36, v36
    v_exp_f32 v37, v37
    v_exp_f32 v38, v38
    v_exp_f32 v39, v39
    v_exp_f32 v40, v40
    v_exp_f32 v41, v41
    v_smfmac_f32_32x32x32_bf16 v[56:71], v[132:135], v[32:39], v6
    v_exp_f32 v42, v42
    v_exp_f32 v43, v43
    v_exp_f32 v44, v44
    s_waitcnt vmcnt(11)
    v_mfma_f32_32x32x16_bf16 v[24:39], v[88:91], v[16:19], 0
    v_exp_f32 v45, v45
    v_exp_f32 v46, v46
    v_exp_f32 v47, v47
    v_exp_f32 v48, v48
    v_exp_f32 v49, v49
    v_smfmac_f32_32x32x32_bf16 v[72:87], v[128:131], v[40:47], v6
    s_add_u32 m0, s85, 5120
    s_add_u32 s77, s82, 8192
    buffer_load_dwordx4 v2, s[28:31], s77 offen lds
    v_exp_f32 v50, v50
    v_exp_f32 v51, v51
    v_exp_f32 v52, v52
    v_exp_f32 v53, v53
    v_exp_f32 v54, v54
    v_exp_f32 v55, v55
    v_exp_f32 v24, v24
    v_exp_f32 v25, v25
    v_smfmac_f32_32x32x32_bf16 v[72:87], v[132:135], v[48:55], v6
    buffer_load_dwordx4 v[124:127], v4, s[36:39], s74 offen offset:2048
    s_add_u32 s74, s74, 4096
    s_mov_b64 exec, s[88:89]
    buffer_load_dwordx4 v[128:131], v5, s[36:39], s81 offen offset:3072
    buffer_load_dwordx4 v[132:135], v5, s[36:39], s81 offen offset:3584
    s_mov_b64 exec, -1
    s_add_u32 s81, s81, 4096
    v_exp_f32 v26, v26
    v_exp_f32 v27, v27
    v_exp_f32 v28, v28
    v_mfma_f32_32x32x16_bf16 v[40:55], v[88:91], v[20:23], 0
    v_exp_f32 v29, v29
    v_exp_f32 v30, v30
    v_exp_f32 v31, v31
    v_exp_f32 v32, v32
    v_exp_f32 v33, v33
    s_waitcnt vmcnt(13)
    v_smfmac_f32_32x32x32_bf16 v[56:71], v[92:95], v[24:31], v6
    s_add_u32 m0, s85, 6144
    s_add_u32 s77, s82, 16384
    buffer_load_dwordx4 v2, s[28:31], s77 offen lds
    s_mov_b64 exec, 0xff00ff
    buffer_load_dword v15, v140, s[36:39], 0 offen
    s_mov_b64 exec, -1
    v_exp_f32 v34, v34
    v_exp_f32 v35, v35
    v_exp_f32 v36, v36
    v_exp_f32 v37, v37
    v_exp_f32 v38, v38
    v_exp_f32 v39, v39
    v_exp_f32 v40, v40
    v_exp_f32 v41, v41
    v_smfmac_f32_32x32x32_bf16 v[56:71], v[96:99], v[32:39], v6
    v_exp_f32 v42, v42
    v_exp_f32 v43, v43
    v_exp_f32 v44, v44
    s_waitcnt vmcnt(12)
    v_mfma_f32_32x32x16_bf16 v[24:39], v[100:103], v[16:19], 0
    v_exp_f32 v45, v45
    v_exp_f32 v46, v46
    v_exp_f32 v47, v47
    v_exp_f32 v48, v48
    v_exp_f32 v49, v49
    v_smfmac_f32_32x32x32_bf16 v[72:87], v[92:95], v[40:47], v6
    ds_read_b64_tr_b16 v[144:145], v8 offset:0
    ds_read_b64_tr_b16 v[146:147], v8 offset:1024
    ds_read_b64_tr_b16 v[200:201], v9 offset:0
    ds_read_b64_tr_b16 v[202:203], v9 offset:1024
    s_add_u32 m0, s85, 7168
    s_add_u32 s77, s82, 24576
    buffer_load_dwordx4 v2, s[28:31], s77 offen lds
    v_exp_f32 v50, v50
    v_exp_f32 v51, v51
    v_exp_f32 v52, v52
    v_exp_f32 v53, v53
    v_exp_f32 v54, v54
    v_exp_f32 v55, v55
    v_exp_f32 v24, v24
    v_exp_f32 v25, v25
    v_smfmac_f32_32x32x32_bf16 v[72:87], v[96:99], v[48:55], v6
    buffer_load_dwordx4 v[88:91], v4, s[36:39], s74 offen offset:0
    s_mov_b64 exec, s[88:89]
    buffer_load_dwordx4 v[92:95], v5, s[36:39], s81 offen offset:1024
    buffer_load_dwordx4 v[96:99], v5, s[36:39], s81 offen offset:1536
    s_mov_b64 exec, -1
    v_exp_f32 v26, v26
    v_exp_f32 v27, v27
    v_exp_f32 v28, v28
    v_mfma_f32_32x32x16_bf16 v[40:55], v[100:103], v[20:23], 0
    v_exp_f32 v29, v29
    v_exp_f32 v30, v30
    v_exp_f32 v31, v31
    v_exp_f32 v32, v32
    v_exp_f32 v33, v33
    s_waitcnt vmcnt(14)
    v_smfmac_f32_32x32x32_bf16 v[56:71], v[104:107], v[24:31], v6
    ds_read_b64_tr_b16 v[148:149], v8 offset:2048
    ds_read_b64_tr_b16 v[150:151], v8 offset:3072
    ds_read_b64_tr_b16 v[204:205], v9 offset:2048
    ds_read_b64_tr_b16 v[206:207], v9 offset:3072
    v_exp_f32 v34, v34
    v_exp_f32 v35, v35
    v_exp_f32 v36, v36
    v_exp_f32 v37, v37
    v_exp_f32 v38, v38
    v_exp_f32 v39, v39
    v_exp_f32 v40, v40
    v_exp_f32 v41, v41
    v_smfmac_f32_32x32x32_bf16 v[56:71], v[108:111], v[32:39], v6
    v_exp_f32 v42, v42
    v_exp_f32 v43, v43
    v_exp_f32 v44, v44
    s_waitcnt vmcnt(13)
    v_mfma_f32_32x32x16_bf16 v[24:39], v[112:115], v[16:19], 0
    v_exp_f32 v45, v45
    v_exp_f32 v46, v46
    v_exp_f32 v47, v47
    v_exp_f32 v48, v48
    v_exp_f32 v49, v49
    v_smfmac_f32_32x32x32_bf16 v[72:87], v[104:107], v[40:47], v6
    v_exp_f32 v50, v50
    v_exp_f32 v51, v51
    v_exp_f32 v52, v52
    v_exp_f32 v53, v53
    v_exp_f32 v54, v54
    v_exp_f32 v55, v55
    v_exp_f32 v24, v24
    v_exp_f32 v25, v25
    v_smfmac_f32_32x32x32_bf16 v[72:87], v[108:111], v[48:55], v6
    buffer_load_dwordx4 v[100:103], v4, s[36:39], s74 offen offset:2048
    s_add_u32 s74, s74, 4096
    s_mov_b64 exec, s[88:89]
    buffer_load_dwordx4 v[104:107], v5, s[36:39], s81 offen offset:3072
    buffer_load_dwordx4 v[108:111], v5, s[36:39], s81 offen offset:3584
    s_mov_b64 exec, -1
    s_add_u32 s81, s81, 4096
    v_exp_f32 v26, v26
    v_exp_f32 v27, v27
    v_exp_f32 v28, v28
    v_mfma_f32_32x32x16_bf16 v[40:55], v[112:115], v[20:23], 0
    v_exp_f32 v29, v29
    v_exp_f32 v30, v30
    v_exp_f32 v31, v31
    v_exp_f32 v32, v32
    v_exp_f32 v33, v33
    s_waitcnt vmcnt(14)
    v_smfmac_f32_32x32x32_bf16 v[56:71], v[116:119], v[24:31], v6
    s_waitcnt lgkmcnt(0)
    s_add_u32 s82, s82, s86
    s_sub_u32 s77, s82, 1835008
    s_cselect_b32 s82, s82, s77
    s_add_u32 m0, s85, 0
    s_add_u32 s77, s82, 0
    buffer_load_dwordx4 v2, s[28:31], s77 offen lds
    v_exp_f32 v34, v34
    v_exp_f32 v35, v35
    v_exp_f32 v36, v36
    v_exp_f32 v37, v37
    v_exp_f32 v38, v38
    v_exp_f32 v39, v39
    v_exp_f32 v40, v40
    v_exp_f32 v41, v41
    v_smfmac_f32_32x32x32_bf16 v[56:71], v[120:123], v[32:39], v6
    v_exp_f32 v42, v42
    v_exp_f32 v43, v43
    v_exp_f32 v44, v44
    s_waitcnt vmcnt(12)
    v_mfma_f32_32x32x16_bf16 v[24:39], v[124:127], v[16:19], 0
    v_exp_f32 v45, v45
    v_exp_f32 v46, v46
    v_exp_f32 v47, v47
    v_exp_f32 v48, v48
    v_exp_f32 v49, v49
    v_smfmac_f32_32x32x32_bf16 v[72:87], v[116:119], v[40:47], v6
    s_add_u32 m0, s85, 1024
    s_add_u32 s77, s82, 8192
    buffer_load_dwordx4 v2, s[28:31], s77 offen lds
    v_exp_f32 v50, v50
    v_exp_f32 v51, v51
    v_exp_f32 v52, v52
    v_exp_f32 v53, v53
    v_exp_f32 v54, v54
    v_exp_f32 v55, v55
    v_exp_f32 v24, v24
    v_exp_f32 v25, v25
    v_smfmac_f32_32x32x32_bf16 v[72:87], v[120:123], v[48:55], v6
    buffer_load_dwordx4 v[112:115], v4, s[36:39], s74 offen offset:0
    s_mov_b64 exec, s[88:89]
    buffer_load_dwordx4 v[116:119], v5, s[36:39], s81 offen offset:1024
    buffer_load_dwordx4 v[120:123], v5, s[36:39], s81 offen offset:1536
    s_mov_b64 exec, -1
    v_exp_f32 v26, v26
    v_exp_f32 v27, v27
    v_exp_f32 v28, v28
    v_mfma_f32_32x32x16_bf16 v[40:55], v[124:127], v[20:23], 0
    v_exp_f32 v29, v29
    v_exp_f32 v30, v30
    v_exp_f32 v31, v31
    v_exp_f32 v32, v32
    v_exp_f32 v33, v33
    s_waitcnt vmcnt(14)
    v_smfmac_f32_32x32x32_bf16 v[56:71], v[128:131], v[24:31], v6
    s_add_u32 m0, s85, 2048
    s_add_u32 s77, s82, 16384
    buffer_load_dwordx4 v2, s[28:31], s77 offen lds
    v_exp_f32 v34, v34
    v_exp_f32 v35, v35
    v_exp_f32 v36, v36
    v_exp_f32 v37, v37
    v_exp_f32 v38, v38
    v_exp_f32 v39, v39
    v_exp_f32 v40, v40
    v_exp_f32 v41, v41
    v_smfmac_f32_32x32x32_bf16 v[56:71], v[132:135], v[32:39], v6
    v_exp_f32 v42, v42
    v_exp_f32 v43, v43
    v_exp_f32 v44, v44
    s_waitcnt vmcnt(11)
    v_mfma_f32_32x32x16_bf16 v[24:39], v[88:91], v[16:19], 0
    v_exp_f32 v45, v45
    v_exp_f32 v46, v46
    v_exp_f32 v47, v47
    v_exp_f32 v48, v48
    v_exp_f32 v49, v49
    v_smfmac_f32_32x32x32_bf16 v[72:87], v[128:131], v[40:47], v6
    ds_read_b64_tr_b16 v[152:153], v8 offset:4096
    ds_read_b64_tr_b16 v[154:155], v8 offset:5120
    ds_read_b64_tr_b16 v[208:209], v9 offset:4096
    ds_read_b64_tr_b16 v[210:211], v9 offset:5120
    s_add_u32 m0, s85, 3072
    s_add_u32 s77, s82, 24576
    buffer_load_dwordx4 v2, s[28:31], s77 offen lds
    s_mov_b64 exec, 0xff00
    buffer_load_dword v142, v140, s[32:35], 0 offen
    s_mov_b64 exec, -1
    v_exp_f32 v50, v50
    v_exp_f32 v51, v51
    v_exp_f32 v52, v52
    v_exp_f32 v53, v53
    v_exp_f32 v54, v54
    v_exp_f32 v55, v55
    v_exp_f32 v24, v24
    v_exp_f32 v25, v25
    v_smfmac_f32_32x32x32_bf16 v[72:87], v[132:135], v[48:55], v6
    buffer_load_dwordx4 v[124:127], v4, s[36:39], s74 offen offset:2048
    s_add_u32 s74, s74, 4096
    s_mov_b64 exec, s[88:89]
    buffer_load_dwordx4 v[128:131], v5, s[36:39], s81 offen offset:3072
    buffer_load_dwordx4 v[132:135], v5, s[36:39], s81 offen offset:3584
    s_mov_b64 exec, -1
    s_add_u32 s81, s81, 4096
    v_exp_f32 v26, v26
    v_exp_f32 v27, v27
    v_exp_f32 v28, v28
    v_mfma_f32_32x32x16_bf16 v[40:55], v[88:91], v[20:23], 0
    v_exp_f32 v29, v29
    v_exp_f32 v30, v30
    v_exp_f32 v31, v31
    v_exp_f32 v32, v32
    v_exp_f32 v33, v33
    s_waitcnt vmcnt(14)
    v_smfmac_f32_32x32x32_bf16 v[56:71], v[92:95], v[24:31], v6
    ds_read_b64_tr_b16 v[156:157], v8 offset:6144
    ds_read_b64_tr_b16 v[158:159], v8 offset:7168
    ds_read_b64_tr_b16 v[212:213], v9 offset:6144
    ds_read_b64_tr_b16 v[214:215], v9 offset:7168
    v_exp_f32 v34, v34
    v_exp_f32 v35, v35
    v_exp_f32 v36, v36
    v_exp_f32 v37, v37
    v_exp_f32 v38, v38
    v_exp_f32 v39, v39
    v_exp_f32 v40, v40
    v_exp_f32 v41, v41
    v_smfmac_f32_32x32x32_bf16 v[56:71], v[96:99], v[32:39], v6
    v_exp_f32 v42, v42
    v_exp_f32 v43, v43
    v_exp_f32 v44, v44
    s_waitcnt vmcnt(13)
    v_mfma_f32_32x32x16_bf16 v[24:39], v[100:103], v[16:19], 0
    v_exp_f32 v45, v45
    v_exp_f32 v46, v46
    v_exp_f32 v47, v47
    v_exp_f32 v48, v48
    v_exp_f32 v49, v49
    v_smfmac_f32_32x32x32_bf16 v[72:87], v[92:95], v[40:47], v6
    v_exp_f32 v50, v50
    v_exp_f32 v51, v51
    v_exp_f32 v52, v52
    v_exp_f32 v53, v53
    v_exp_f32 v54, v54
    v_exp_f32 v55, v55
    v_exp_f32 v24, v24
    v_exp_f32 v25, v25
    v_smfmac_f32_32x32x32_bf16 v[72:87], v[96:99], v[48:55], v6
    buffer_load_dwordx4 v[88:91], v4, s[36:39], s74 offen offset:0
    s_mov_b64 exec, s[88:89]
    buffer_load_dwordx4 v[92:95], v5, s[36:39], s81 offen offset:1024
    buffer_load_dwordx4 v[96:99], v5, s[36:39], s81 offen offset:1536
    s_mov_b64 exec, -1
    v_exp_f32 v26, v26
    v_exp_f32 v27, v27
    v_exp_f32 v28, v28
    v_mfma_f32_32x32x16_bf16 v[40:55], v[100:103], v[20:23], 0
    v_exp_f32 v29, v29
    v_exp_f32 v30, v30
    v_exp_f32 v31, v31
    v_exp_f32 v32, v32
    v_exp_f32 v33, v33
    s_waitcnt vmcnt(14)
    v_smfmac_f32_32x32x32_bf16 v[56:71], v[104:107], v[24:31], v6
    s_waitcnt lgkmcnt(0)
    s_add_u32 s82, s82, s86
    s_sub_u32 s77, s82, 1835008
    s_cselect_b32 s82, s82, s77
    s_add_u32 m0, s85, 4096
    s_add_u32 s77, s82, 0
    buffer_load_dwordx4 v2, s[28:31], s77 offen lds
    v_exp_f32 v34, v34
    v_exp_f32 v35, v35
    v_exp_f32 v36, v36
    v_exp_f32 v37, v37
    v_exp_f32 v38, v38
    v_exp_f32 v39, v39
    v_exp_f32 v40, v40
    v_exp_f32 v41, v41
    v_smfmac_f32_32x32x32_bf16 v[56:71], v[108:111], v[32:39], v6
    v_exp_f32 v42, v42
    v_exp_f32 v43, v43
    v_exp_f32 v44, v44
    s_waitcnt vmcnt(12)
    v_mfma_f32_32x32x16_bf16 v[24:39], v[112:115], v[16:19], 0
    v_exp_f32 v45, v45
    v_exp_f32 v46, v46
    v_exp_f32 v47, v47
    v_exp_f32 v48, v48
    v_exp_f32 v49, v49
    v_smfmac_f32_32x32x32_bf16 v[72:87], v[104:107], v[40:47], v6
    s_add_u32 m0, s85, 5120
    s_add_u32 s77, s82, 8192
    buffer_load_dwordx4 v2, s[28:31], s77 offen lds
    v_exp_f32 v50, v50
    v_exp_f32 v51, v51
    v_exp_f32 v52, v52
    v_exp_f32 v53, v53
    v_exp_f32 v54, v54
    v_exp_f32 v55, v55
    v_exp_f32 v24, v24
    v_exp_f32 v25, v25
    v_smfmac_f32_32x32x32_bf16 v[72:87], v[108:111], v[48:55], v6
    buffer_load_dwordx4 v[100:103], v4, s[36:39], s74 offen offset:2048
    s_add_u32 s74, s74, 4096
    s_mov_b64 exec, s[88:89]
    buffer_load_dwordx4 v[104:107], v5, s[36:39], s81 offen offset:3072
    buffer_load_dwordx4 v[108:111], v5, s[36:39], s81 offen offset:3584
    s_mov_b64 exec, -1
    s_add_u32 s81, s81, 4096
    v_exp_f32 v26, v26
    v_exp_f32 v27, v27
    v_exp_f32 v28, v28
    v_mfma_f32_32x32x16_bf16 v[40:55], v[112:115], v[20:23], 0
    v_exp_f32 v29, v29
    v_exp_f32 v30, v30
    v_exp_f32 v31, v31
    v_exp_f32 v32, v32
    v_exp_f32 v33, v33
    s_waitcnt vmcnt(14)
    v_smfmac_f32_32x32x32_bf16 v[56:71], v[116:119], v[24:31], v6
    s_add_u32 m0, s85, 6144
    s_add_u32 s77, s82, 16384
    buffer_load_dwordx4 v2, s[28:31], s77 offen lds
    v_exp_f32 v34, v34
    v_exp_f32 v35, v35
    v_exp_f32 v36, v36
    v_exp_f32 v37, v37
    v_exp_f32 v38, v38
    v_exp_f32 v39, v39
    v_exp_f32 v40, v40
    v_exp_f32 v41, v41
    v_smfmac_f32_32x32x32_bf16 v[56:71], v[120:123], v[32:39], v6
    v_exp_f32 v42, v42
    v_exp_f32 v43, v43
    v_exp_f32 v44, v44
    s_waitcnt vmcnt(11)
    v_mfma_f32_32x32x16_bf16 v[24:39], v[124:127], v[16:19], 0
    v_exp_f32 v45, v45
    v_exp_f32 v46, v46
    v_exp_f32 v47, v47
    v_exp_f32 v48, v48
    v_exp_f32 v49, v49
    v_smfmac_f32_32x32x32_bf16 v[72:87], v[116:119], v[40:47], v6
    ds_read_b64_tr_b16 v[160:161], v8 offset:0
    ds_read_b64_tr_b16 v[162:163], v8 offset:1024
    ds_read_b64_tr_b16 v[216:217], v9 offset:0
    ds_read_b64_tr_b16 v[218:219], v9 offset:1024
    s_add_u32 m0, s85, 7168
    s_add_u32 s77, s82, 24576
    buffer_load_dwordx4 v2, s[28:31], s77 offen lds
    v_exp_f32 v50, v50
    v_exp_f32 v51, v51
    v_exp_f32 v52, v52
    v_exp_f32 v53, v53
    v_exp_f32 v54, v54
    v_exp_f32 v55, v55
    v_exp_f32 v24, v24
    v_exp_f32 v25, v25
    v_smfmac_f32_32x32x32_bf16 v[72:87], v[120:123], v[48:55], v6
    buffer_load_dwordx4 v[112:115], v4, s[36:39], s74 offen offset:0
    s_mov_b64 exec, s[88:89]
    buffer_load_dwordx4 v[116:119], v5, s[36:39], s81 offen offset:1024
    buffer_load_dwordx4 v[120:123], v5, s[36:39], s81 offen offset:1536
    s_mov_b64 exec, -1
    v_exp_f32 v26, v26
    v_exp_f32 v27, v27
    v_exp_f32 v28, v28
    v_mfma_f32_32x32x16_bf16 v[40:55], v[124:127], v[20:23], 0
    v_exp_f32 v29, v29
    v_exp_f32 v30, v30
    v_exp_f32 v31, v31
    v_exp_f32 v32, v32
    v_exp_f32 v33, v33
    s_waitcnt vmcnt(13)
    v_smfmac_f32_32x32x32_bf16 v[56:71], v[128:131], v[24:31], v6
    ds_read_b64_tr_b16 v[164:165], v8 offset:2048
    ds_read_b64_tr_b16 v[166:167], v8 offset:3072
    ds_read_b64_tr_b16 v[220:221], v9 offset:2048
    ds_read_b64_tr_b16 v[222:223], v9 offset:3072
    v_exp_f32 v34, v34
    v_exp_f32 v35, v35
    v_exp_f32 v36, v36
    v_exp_f32 v37, v37
    v_exp_f32 v38, v38
    v_exp_f32 v39, v39
    v_exp_f32 v40, v40
    v_exp_f32 v41, v41
    v_smfmac_f32_32x32x32_bf16 v[56:71], v[132:135], v[32:39], v6
    v_exp_f32 v42, v42
    v_exp_f32 v43, v43
    v_exp_f32 v44, v44
    s_waitcnt vmcnt(12)
    v_mfma_f32_32x32x16_bf16 v[24:39], v[88:91], v[16:19], 0
    v_exp_f32 v45, v45
    v_exp_f32 v46, v46
    v_exp_f32 v47, v47
    v_exp_f32 v48, v48
    v_exp_f32 v49, v49
    v_smfmac_f32_32x32x32_bf16 v[72:87], v[128:131], v[40:47], v6
    v_exp_f32 v50, v50
    v_exp_f32 v51, v51
    v_exp_f32 v52, v52
    v_exp_f32 v53, v53
    v_exp_f32 v54, v54
    v_exp_f32 v55, v55
    v_exp_f32 v24, v24
    v_exp_f32 v25, v25
    v_smfmac_f32_32x32x32_bf16 v[72:87], v[132:135], v[48:55], v6
    buffer_load_dwordx4 v[124:127], v4, s[36:39], s74 offen offset:2048
    s_add_u32 s74, s74, 4096
    s_mov_b64 exec, s[88:89]
    buffer_load_dwordx4 v[128:131], v5, s[36:39], s81 offen offset:3072
    buffer_load_dwordx4 v[132:135], v5, s[36:39], s81 offen offset:3584
    s_mov_b64 exec, -1
    s_add_u32 s81, s81, 4096
    v_exp_f32 v26, v26
    v_exp_f32 v27, v27
    v_exp_f32 v28, v28
    v_mfma_f32_32x32x16_bf16 v[40:55], v[88:91], v[20:23], 0
    v_exp_f32 v29, v29
    v_exp_f32 v30, v30
    v_exp_f32 v31, v31
    v_exp_f32 v32, v32
    v_exp_f32 v33, v33
    s_waitcnt vmcnt(13)
    v_smfmac_f32_32x32x32_bf16 v[56:71], v[92:95], v[24:31], v6
    s_waitcnt lgkmcnt(0)
    s_add_u32 s82, s82, s86
    s_sub_u32 s77, s82, 1835008
    s_cselect_b32 s82, s82, s77
    s_add_u32 m0, s85, 0
    s_add_u32 s77, s82, 0
    buffer_load_dwordx4 v2, s[28:31], s77 offen lds
    v_exp_f32 v34, v34
    v_exp_f32 v35, v35
    v_exp_f32 v36, v36
    v_exp_f32 v37, v37
    v_exp_f32 v38, v38
    v_exp_f32 v39, v39
    v_exp_f32 v40, v40
    v_exp_f32 v41, v41
    v_smfmac_f32_32x32x32_bf16 v[56:71], v[96:99], v[32:39], v6
    v_exp_f32 v42, v42
    v_exp_f32 v43, v43
    v_exp_f32 v44, v44
    s_waitcnt vmcnt(11)
    v_mfma_f32_32x32x16_bf16 v[24:39], v[100:103], v[16:19], 0
    v_exp_f32 v45, v45
    v_exp_f32 v46, v46
    v_exp_f32 v47, v47
    v_exp_f32 v48, v48
    v_exp_f32 v49, v49
    v_smfmac_f32_32x32x32_bf16 v[72:87], v[92:95], v[40:47], v6
    s_add_u32 m0, s85, 1024
    s_add_u32 s77, s82, 8192
    buffer_load_dwordx4 v2, s[28:31], s77 offen lds
    v_exp_f32 v50, v50
    v_exp_f32 v51, v51
    v_exp_f32 v52, v52
    v_exp_f32 v53, v53
    v_exp_f32 v54, v54
    v_exp_f32 v55, v55
    v_exp_f32 v24, v24
    v_exp_f32 v25, v25
    v_smfmac_f32_32x32x32_bf16 v[72:87], v[96:99], v[48:55], v6
    buffer_load_dwordx4 v[88:91], v4, s[36:39], s74 offen offset:0
    s_mov_b64 exec, s[88:89]
    buffer_load_dwordx4 v[92:95], v5, s[36:39], s81 offen offset:1024
    buffer_load_dwordx4 v[96:99], v5, s[36:39], s81 offen offset:1536
    s_mov_b64 exec, -1
    v_exp_f32 v26, v26
    v_exp_f32 v27, v27
    v_exp_f32 v28, v28
    v_mfma_f32_32x32x16_bf16 v[40:55], v[100:103], v[20:23], 0
    v_exp_f32 v29, v29
    v_exp_f32 v30, v30
    v_exp_f32 v31, v31
    v_exp_f32 v32, v32
    v_exp_f32 v33, v33
    s_waitcnt vmcnt(13)
    v_smfmac_f32_32x32x32_bf16 v[56:71], v[104:107], v[24:31], v6
    s_add_u32 m0, s85, 2048
    s_add_u32 s77, s82, 16384
    buffer_load_dwordx4 v2, s[28:31], s77 offen lds
    v_exp_f32 v34, v34
    v_exp_f32 v35, v35
    v_exp_f32 v36, v36
    v_exp_f32 v37, v37
    v_exp_f32 v38, v38
    v_exp_f32 v39, v39
    v_exp_f32 v40, v40
    v_exp_f32 v41, v41
    v_smfmac_f32_32x32x32_bf16 v[56:71], v[108:111], v[32:39], v6
    v_exp_f32 v42, v42
    v_exp_f32 v43, v43
    v_exp_f32 v44, v44
    s_waitcnt vmcnt(11)
    v_mfma_f32_32x32x16_bf16 v[24:39], v[112:115], v[16:19], 0
    v_exp_f32 v45, v45
    v_exp_f32 v46, v46
    v_exp_f32 v47, v47
    v_exp_f32 v48, v48
    v_exp_f32 v49, v49
    v_smfmac_f32_32x32x32_bf16 v[72:87], v[104:107], v[40:47], v6
    ds_read_b64_tr_b16 v[168:169], v8 offset:4096
    ds_read_b64_tr_b16 v[170:171], v8 offset:5120
    ds_read_b64_tr_b16 v[224:225], v9 offset:4096
    ds_read_b64_tr_b16 v[226:227], v9 offset:5120
    s_add_u32 m0, s85, 3072
    s_add_u32 s77, s82, 24576
    buffer_load_dwordx4 v2, s[28:31], s77 offen lds
    v_exp_f32 v50, v50
    v_exp_f32 v51, v51
    v_exp_f32 v52, v52
    v_exp_f32 v53, v53
    v_exp_f32 v54, v54
    v_exp_f32 v55, v55
    v_exp_f32 v24, v24
    v_exp_f32 v25, v25
    v_smfmac_f32_32x32x32_bf16 v[72:87], v[108:111], v[48:55], v6
    buffer_load_dwordx4 v[100:103], v4, s[36:39], s74 offen offset:2048
    s_add_u32 s74, s74, 4096
    s_mov_b64 exec, s[88:89]
    buffer_load_dwordx4 v[104:107], v5, s[36:39], s81 offen offset:3072
    buffer_load_dwordx4 v[108:111], v5, s[36:39], s81 offen offset:3584
    s_mov_b64 exec, -1
    s_add_u32 s81, s81, 4096
    v_exp_f32 v26, v26
    v_exp_f32 v27, v27
    v_exp_f32 v28, v28
    v_mfma_f32_32x32x16_bf16 v[40:55], v[112:115], v[20:23], 0
    v_exp_f32 v29, v29
    v_exp_f32 v30, v30
    v_exp_f32 v31, v31
    v_exp_f32 v32, v32
    v_exp_f32 v33, v33
    s_waitcnt vmcnt(13)
    v_smfmac_f32_32x32x32_bf16 v[56:71], v[116:119], v[24:31], v6
    ds_read_b64_tr_b16 v[172:173], v8 offset:6144
    ds_read_b64_tr_b16 v[174:175], v8 offset:7168
    ds_read_b64_tr_b16 v[228:229], v9 offset:6144
    ds_read_b64_tr_b16 v[230:231], v9 offset:7168
    v_exp_f32 v34, v34
    v_exp_f32 v35, v35
    v_exp_f32 v36, v36
    v_exp_f32 v37, v37
    v_exp_f32 v38, v38
    v_exp_f32 v39, v39
    v_exp_f32 v40, v40
    v_exp_f32 v41, v41
    v_smfmac_f32_32x32x32_bf16 v[56:71], v[120:123], v[32:39], v6
    v_exp_f32 v42, v42
    v_exp_f32 v43, v43
    v_exp_f32 v44, v44
    s_waitcnt vmcnt(12)
    v_mfma_f32_32x32x16_bf16 v[24:39], v[124:127], v[16:19], 0
    v_exp_f32 v45, v45
    v_exp_f32 v46, v46
    v_exp_f32 v47, v47
    v_exp_f32 v48, v48
    v_exp_f32 v49, v49
    v_smfmac_f32_32x32x32_bf16 v[72:87], v[116:119], v[40:47], v6
    v_exp_f32 v50, v50
    v_exp_f32 v51, v51
    v_exp_f32 v52, v52
    v_exp_f32 v53, v53
    v_exp_f32 v54, v54
    v_exp_f32 v55, v55
    v_exp_f32 v24, v24
    v_exp_f32 v25, v25
    v_smfmac_f32_32x32x32_bf16 v[72:87], v[120:123], v[48:55], v6
    buffer_load_dwordx4 v[112:115], v4, s[36:39], s74 offen offset:0
    s_mov_b64 exec, s[88:89]
    buffer_load_dwordx4 v[116:119], v5, s[36:39], s81 offen offset:1024
    buffer_load_dwordx4 v[120:123], v5, s[36:39], s81 offen offset:1536
    s_mov_b64 exec, -1
    v_exp_f32 v26, v26
    v_exp_f32 v27, v27
    v_exp_f32 v28, v28
    v_mfma_f32_32x32x16_bf16 v[40:55], v[124:127], v[20:23], 0
    v_exp_f32 v29, v29
    v_exp_f32 v30, v30
    v_exp_f32 v31, v31
    v_exp_f32 v32, v32
    v_exp_f32 v33, v33
    s_waitcnt vmcnt(13)
    v_smfmac_f32_32x32x32_bf16 v[56:71], v[128:131], v[24:31], v6
    s_waitcnt lgkmcnt(0)
    s_add_u32 s82, s82, s86
    s_sub_u32 s77, s82, 1835008
    s_cselect_b32 s82, s82, s77
    s_add_u32 m0, s85, 4096
    s_add_u32 s77, s82, 0
    buffer_load_dwordx4 v2, s[28:31], s77 offen lds
    v_exp_f32 v34, v34
    v_exp_f32 v35, v35
    v_exp_f32 v36, v36
    v_exp_f32 v37, v37
    v_exp_f32 v38, v38
    v_exp_f32 v39, v39
    v_exp_f32 v40, v40
    v_exp_f32 v41, v41
    v_smfmac_f32_32x32x32_bf16 v[56:71], v[132:135], v[32:39], v6
    v_exp_f32 v42, v42
    v_exp_f32 v43, v43
    v_exp_f32 v44, v44
    s_waitcnt vmcnt(11)
    v_mfma_f32_32x32x16_bf16 v[24:39], v[88:91], v[16:19], 0
    v_exp_f32 v45, v45
    v_exp_f32 v46, v46
    v_exp_f32 v47, v47
    v_exp_f32 v48, v48
    v_exp_f32 v49, v49
    v_smfmac_f32_32x32x32_bf16 v[72:87], v[128:131], v[40:47], v6
    s_add_u32 m0, s85, 5120
    s_add_u32 s77, s82, 8192
    buffer_load_dwordx4 v2, s[28:31], s77 offen lds
    v_exp_f32 v50, v50
    v_exp_f32 v51, v51
    v_exp_f32 v52, v52
    v_exp_f32 v53, v53
    v_exp_f32 v54, v54
    v_exp_f32 v55, v55
    v_exp_f32 v24, v24
    v_exp_f32 v25, v25
    v_smfmac_f32_32x32x32_bf16 v[72:87], v[132:135], v[48:55], v6
    buffer_load_dwordx4 v[124:127], v4, s[36:39], s74 offen offset:2048
    s_add_u32 s74, s74, 4096
    s_mov_b64 exec, s[88:89]
    buffer_load_dwordx4 v[128:131], v5, s[36:39], s81 offen offset:3072
    buffer_load_dwordx4 v[132:135], v5, s[36:39], s81 offen offset:3584
    s_mov_b64 exec, -1
    s_add_u32 s81, s81, 4096
    v_exp_f32 v26, v26
    v_exp_f32 v27, v27
    v_exp_f32 v28, v28
    v_mfma_f32_32x32x16_bf16 v[40:55], v[88:91], v[20:23], 0
    v_exp_f32 v29, v29
    v_exp_f32 v30, v30
    v_exp_f32 v31, v31
    v_exp_f32 v32, v32
    v_exp_f32 v33, v33
    s_waitcnt vmcnt(13)
    v_smfmac_f32_32x32x32_bf16 v[56:71], v[92:95], v[24:31], v6
    s_add_u32 m0, s85, 6144
    s_add_u32 s77, s82, 16384
    buffer_load_dwordx4 v2, s[28:31], s77 offen lds
    v_exp_f32 v34, v34
    v_exp_f32 v35, v35
    v_exp_f32 v36, v36
    v_exp_f32 v37, v37
    v_exp_f32 v38, v38
    v_exp_f32 v39, v39
    v_exp_f32 v40, v40
    v_exp_f32 v41, v41
    v_smfmac_f32_32x32x32_bf16 v[56:71], v[96:99], v[32:39], v6
    v_exp_f32 v42, v42
    v_exp_f32 v43, v43
    v_exp_f32 v44, v44
    s_waitcnt vmcnt(11)
    v_mfma_f32_32x32x16_bf16 v[24:39], v[100:103], v[16:19], 0
    v_exp_f32 v45, v45
    v_exp_f32 v46, v46
    v_exp_f32 v47, v47
    v_exp_f32 v48, v48
    v_exp_f32 v49, v49
    v_smfmac_f32_32x32x32_bf16 v[72:87], v[92:95], v[40:47], v6
    ds_read_b64_tr_b16 v[176:177], v8 offset:0
    ds_read_b64_tr_b16 v[178:179], v8 offset:1024
    ds_read_b64_tr_b16 v[232:233], v9 offset:0
    ds_read_b64_tr_b16 v[234:235], v9 offset:1024
    s_add_u32 m0, s85, 7168
    s_add_u32 s77, s82, 24576
    buffer_load_dwordx4 v2, s[28:31], s77 offen lds
    v_exp_f32 v50, v50
    v_exp_f32 v51, v51
    v_exp_f32 v52, v52
    v_exp_f32 v53, v53
    v_exp_f32 v54, v54
    v_exp_f32 v55, v55
    v_exp_f32 v24, v24
    v_exp_f32 v25, v25
    v_smfmac_f32_32x32x32_bf16 v[72:87], v[96:99], v[48:55], v6
    buffer_load_dwordx4 v[88:91], v4, s[36:39], s74 offen offset:0
    s_mov_b64 exec, s[88:89]
    buffer_load_dwordx4 v[92:95], v5, s[36:39], s81 offen offset:1024
    buffer_load_dwordx4 v[96:99], v5, s[36:39], s81 offen offset:1536
    s_mov_b64 exec, -1
    v_exp_f32 v26, v26
    v_exp_f32 v27, v27
    v_exp_f32 v28, v28
    v_mfma_f32_32x32x16_bf16 v[40:55], v[100:103], v[20:23], 0
    v_exp_f32 v29, v29
    v_exp_f32 v30, v30
    v_exp_f32 v31, v31
    v_exp_f32 v32, v32
    v_exp_f32 v33, v33
    s_waitcnt vmcnt(13)
    v_smfmac_f32_32x32x32_bf16 v[56:71], v[104:107], v[24:31], v6
    ds_read_b64_tr_b16 v[180:181], v8 offset:2048
    ds_read_b64_tr_b16 v[182:183], v8 offset:3072
    ds_read_b64_tr_b16 v[236:237], v9 offset:2048
    ds_read_b64_tr_b16 v[238:239], v9 offset:3072
    v_exp_f32 v34, v34
    v_exp_f32 v35, v35
    v_exp_f32 v36, v36
    v_exp_f32 v37, v37
    v_exp_f32 v38, v38
    v_exp_f32 v39, v39
    v_exp_f32 v40, v40
    v_exp_f32 v41, v41
    v_smfmac_f32_32x32x32_bf16 v[56:71], v[108:111], v[32:39], v6
    v_exp_f32 v42, v42
    v_exp_f32 v43, v43
    v_exp_f32 v44, v44
    s_waitcnt vmcnt(12)
    v_mfma_f32_32x32x16_bf16 v[24:39], v[112:115], v[16:19], 0
    v_exp_f32 v45, v45
    v_exp_f32 v46, v46
    v_exp_f32 v47, v47
    v_exp_f32 v48, v48
    v_exp_f32 v49, v49
    v_smfmac_f32_32x32x32_bf16 v[72:87], v[104:107], v[40:47], v6
    v_exp_f32 v50, v50
    v_exp_f32 v51, v51
    v_exp_f32 v52, v52
    v_exp_f32 v53, v53
    v_exp_f32 v54, v54
    v_exp_f32 v55, v55
    v_exp_f32 v24, v24
    v_exp_f32 v25, v25
    v_smfmac_f32_32x32x32_bf16 v[72:87], v[108:111], v[48:55], v6
    buffer_load_dwordx4 v[100:103], v4, s[36:39], s74 offen offset:2048
    s_add_u32 s74, s74, 4096
    s_mov_b64 exec, s[88:89]
    buffer_load_dwordx4 v[104:107], v5, s[36:39], s81 offen offset:3072
    buffer_load_dwordx4 v[108:111], v5, s[36:39], s81 offen offset:3584
    s_mov_b64 exec, -1
    s_add_u32 s81, s81, 4096
    v_exp_f32 v26, v26
    v_exp_f32 v27, v27
    v_exp_f32 v28, v28
    v_mfma_f32_32x32x16_bf16 v[40:55], v[112:115], v[20:23], 0
    v_exp_f32 v29, v29
    v_exp_f32 v30, v30
    v_exp_f32 v31, v31
    v_exp_f32 v32, v32
    v_exp_f32 v33, v33
    s_waitcnt vmcnt(13)
    v_smfmac_f32_32x32x32_bf16 v[56:71], v[116:119], v[24:31], v6
    s_waitcnt lgkmcnt(0)
    s_add_u32 s82, s82, s86
    s_sub_u32 s77, s82, 1835008
    s_cselect_b32 s82, s82, s77
    s_mul_i32 s76, s63, 229504
    s_lshl_b32 s77, s64, 15
    s_add_u32 s76, s76, s77
    s_cmp_eq_u32 s64, 7
    s_cselect_b32 s82, s82, s76
    s_add_u32 m0, s85, 0
    s_add_u32 s77, s82, 0
    buffer_load_dwordx4 v2, s[28:31], s77 offen lds
    v_exp_f32 v34, v34
    v_exp_f32 v35, v35
    v_exp_f32 v36, v36
    v_exp_f32 v37, v37
    v_exp_f32 v38, v38
    v_exp_f32 v39, v39
    v_exp_f32 v40, v40
    v_exp_f32 v41, v41
    v_smfmac_f32_32x32x32_bf16 v[56:71], v[120:123], v[32:39], v6
    v_exp_f32 v42, v42
    v_exp_f32 v43, v43
    v_exp_f32 v44, v44
    s_waitcnt vmcnt(11)
    v_mfma_f32_32x32x16_bf16 v[24:39], v[124:127], v[16:19], 0
    v_exp_f32 v45, v45
    v_exp_f32 v46, v46
    v_exp_f32 v47, v47
    v_exp_f32 v48, v48
    v_exp_f32 v49, v49
    v_smfmac_f32_32x32x32_bf16 v[72:87], v[116:119], v[40:47], v6
    s_add_u32 m0, s85, 1024
    s_add_u32 s77, s82, 8192
    buffer_load_dwordx4 v2, s[28:31], s77 offen lds
    v_exp_f32 v50, v50
    v_exp_f32 v51, v51
    v_exp_f32 v52, v52
    v_exp_f32 v53, v53
    v_exp_f32 v54, v54
    v_exp_f32 v55, v55
    v_exp_f32 v24, v24
    v_exp_f32 v25, v25
    v_smfmac_f32_32x32x32_bf16 v[72:87], v[120:123], v[48:55], v6
    buffer_load_dwordx4 v[112:115], v4, s[36:39], s74 offen offset:0
    s_mov_b64 exec, s[88:89]
    buffer_load_dwordx4 v[116:119], v5, s[36:39], s81 offen offset:1024
    buffer_load_dwordx4 v[120:123], v5, s[36:39], s81 offen offset:1536
    s_mov_b64 exec, -1
    v_exp_f32 v26, v26
    v_exp_f32 v27, v27
    v_exp_f32 v28, v28
    v_mfma_f32_32x32x16_bf16 v[40:55], v[124:127], v[20:23], 0
    v_exp_f32 v29, v29
    v_exp_f32 v30, v30
    v_exp_f32 v31, v31
    v_exp_f32 v32, v32
    v_exp_f32 v33, v33
    s_waitcnt vmcnt(13)
    v_smfmac_f32_32x32x32_bf16 v[56:71], v[128:131], v[24:31], v6
    s_add_u32 m0, s85, 2048
    s_add_u32 s77, s82, 16384
    buffer_load_dwordx4 v2, s[28:31], s77 offen lds
    v_exp_f32 v34, v34
    v_exp_f32 v35, v35
    v_exp_f32 v36, v36
    v_exp_f32 v37, v37
    v_exp_f32 v38, v38
    v_exp_f32 v39, v39
    v_exp_f32 v40, v40
    v_exp_f32 v41, v41
    v_smfmac_f32_32x32x32_bf16 v[56:71], v[132:135], v[32:39], v6
    v_exp_f32 v42, v42
    v_exp_f32 v43, v43
    v_exp_f32 v44, v44
    s_waitcnt vmcnt(11)
    v_mfma_f32_32x32x16_bf16 v[24:39], v[88:91], v[16:19], 0
    v_exp_f32 v45, v45
    v_exp_f32 v46, v46
    v_exp_f32 v47, v47
    v_exp_f32 v48, v48
    v_exp_f32 v49, v49
    v_smfmac_f32_32x32x32_bf16 v[72:87], v[128:131], v[40:47], v6
    ds_read_b64_tr_b16 v[184:185], v8 offset:4096
    ds_read_b64_tr_b16 v[186:187], v8 offset:5120
    ds_read_b64_tr_b16 v[240:241], v9 offset:4096
    ds_read_b64_tr_b16 v[242:243], v9 offset:5120
    s_add_u32 m0, s85, 3072
    s_add_u32 s77, s82, 24576
    buffer_load_dwordx4 v2, s[28:31], s77 offen lds
    v_exp_f32 v50, v50
    v_exp_f32 v51, v51
    v_exp_f32 v52, v52
    v_exp_f32 v53, v53
    v_exp_f32 v54, v54
    v_exp_f32 v55, v55
    s_setprio 2
    v_exp_f32 v24, v24
    v_exp_f32 v25, v25
    v_smfmac_f32_32x32x32_bf16 v[72:87], v[132:135], v[48:55], v6
    buffer_load_dwordx4 v[124:127], v4, s[36:39], s74 offen offset:2048
    s_add_u32 s74, s74, 4096
    s_mov_b64 exec, s[88:89]
    buffer_load_dwordx4 v[128:131], v5, s[36:39], s81 offen offset:3072
    buffer_load_dwordx4 v[132:135], v5, s[36:39], s81 offen offset:3584
    s_mov_b64 exec, -1
    s_add_u32 s81, s81, 4096
    v_exp_f32 v26, v26
    v_exp_f32 v27, v27
    v_exp_f32 v28, v28
    v_mfma_f32_32x32x16_bf16 v[40:55], v[88:91], v[20:23], 0
    v_exp_f32 v29, v29
    v_exp_f32 v30, v30
    v_exp_f32 v31, v31
    v_exp_f32 v32, v32
    v_exp_f32 v33, v33
    s_waitcnt vmcnt(13)
    v_smfmac_f32_32x32x32_bf16 v[56:71], v[92:95], v[24:31], v6
    ds_read_b64_tr_b16 v[188:189], v8 offset:6144
    ds_read_b64_tr_b16 v[190:191], v8 offset:7168
    ds_read_b64_tr_b16 v[244:245], v9 offset:6144
    ds_read_b64_tr_b16 v[246:247], v9 offset:7168
    v_exp_f32 v34, v34
    v_exp_f32 v35, v35
    v_exp_f32 v36, v36
    v_exp_f32 v37, v37
    v_exp_f32 v38, v38
    v_exp_f32 v39, v39
    v_exp_f32 v40, v40
    v_exp_f32 v41, v41
    v_smfmac_f32_32x32x32_bf16 v[56:71], v[96:99], v[32:39], v6
    v_exp_f32 v42, v42
    v_exp_f32 v43, v43
    v_exp_f32 v44, v44
    s_waitcnt vmcnt(12)
    v_mfma_f32_32x32x16_bf16 v[24:39], v[100:103], v[16:19], 0
    v_exp_f32 v45, v45
    v_exp_f32 v46, v46
    v_exp_f32 v47, v47
    v_exp_f32 v48, v48
    v_exp_f32 v49, v49
    v_smfmac_f32_32x32x32_bf16 v[72:87], v[92:95], v[40:47], v6
    v_exp_f32 v50, v50
    v_exp_f32 v51, v51
    v_exp_f32 v52, v52
    v_exp_f32 v53, v53
    v_exp_f32 v54, v54
    v_exp_f32 v55, v55
    v_exp_f32 v24, v24
    v_exp_f32 v25, v25
    v_smfmac_f32_32x32x32_bf16 v[72:87], v[96:99], v[48:55], v6
    buffer_load_dwordx4 v[88:91], v4, s[36:39], s74 offen offset:0
    s_mov_b64 exec, s[88:89]
    buffer_load_dwordx4 v[92:95], v5, s[36:39], s81 offen offset:1024
    buffer_load_dwordx4 v[96:99], v5, s[36:39], s81 offen offset:1536
    s_mov_b64 exec, -1
    v_exp_f32 v26, v26
    v_exp_f32 v27, v27
    v_exp_f32 v28, v28
    v_mfma_f32_32x32x16_bf16 v[40:55], v[100:103], v[20:23], 0
    v_exp_f32 v29, v29
    v_exp_f32 v30, v30
    v_exp_f32 v31, v31
    v_exp_f32 v32, v32
    v_exp_f32 v33, v33
    s_waitcnt vmcnt(13)
    v_smfmac_f32_32x32x32_bf16 v[56:71], v[104:107], v[24:31], v6
    s_add_u32 m0, s79, 65536
    s_add_u32 s77, s83, 0
    s_mov_b64 exec, s[90:91]
    buffer_load_dwordx4 v3, s[24:27], s77 offen lds
    s_mov_b64 exec, -1
    v_exp_f32 v34, v34
    v_exp_f32 v35, v35
    v_exp_f32 v36, v36
    v_exp_f32 v37, v37
    v_exp_f32 v38, v38
    v_exp_f32 v39, v39
    v_exp_f32 v40, v40
    v_exp_f32 v41, v41
    v_smfmac_f32_32x32x32_bf16 v[56:71], v[108:111], v[32:39], v6
    v_exp_f32 v42, v42
    v_exp_f32 v43, v43
    v_exp_f32 v44, v44
    s_waitcnt vmcnt(11)
    v_mfma_f32_32x32x16_bf16 v[24:39], v[112:115], v[16:19], 0
    v_exp_f32 v45, v45
    v_exp_f32 v46, v46
    v_exp_f32 v47, v47
    v_exp_f32 v48, v48
    v_exp_f32 v49, v49
    v_smfmac_f32_32x32x32_bf16 v[72:87], v[104:107], v[40:47], v6
    s_add_u32 m0, s79, 72704
    s_add_u32 s77, s83, 57344
    s_mov_b64 exec, s[90:91]
    buffer_load_dwordx4 v3, s[24:27], s77 offen lds
    s_mov_b64 exec, -1
    v_exp_f32 v50, v50
    v_exp_f32 v51, v51
    v_exp_f32 v52, v52
    v_exp_f32 v53, v53
    v_exp_f32 v54, v54
    v_exp_f32 v55, v55
    v_exp_f32 v24, v24
    v_exp_f32 v25, v25
    v_smfmac_f32_32x32x32_bf16 v[72:87], v[108:111], v[48:55], v6
    buffer_load_dwordx4 v[100:103], v4, s[36:39], s74 offen offset:2048
    s_add_u32 s74, s74, 4096
    s_mov_b64 exec, s[88:89]
    buffer_load_dwordx4 v[104:107], v5, s[36:39], s81 offen offset:3072
    buffer_load_dwordx4 v[108:111], v5, s[36:39], s81 offen offset:3584
    s_mov_b64 exec, -1
    s_add_u32 s81, s81, 4096
    v_exp_f32 v26, v26
    v_exp_f32 v27, v27
    v_exp_f32 v28, v28
    v_mfma_f32_32x32x16_bf16 v[40:55], v[112:115], v[20:23], 0
    v_exp_f32 v29, v29
    v_exp_f32 v30, v30
    v_exp_f32 v31, v31
    v_exp_f32 v32, v32
    v_exp_f32 v33, v33
    s_waitcnt vmcnt(13)
    v_smfmac_f32_32x32x32_bf16 v[56:71], v[116:119], v[24:31], v6
    s_add_u32 m0, s79, 79872
    s_add_u32 s77, s83, 114688
    s_mov_b64 exec, s[90:91]
    buffer_load_dwordx4 v3, s[24:27], s77 offen lds
    s_mov_b64 exec, -1
    buffer_load_dword v143, v141, s[24:27], 0 offen
    v_exp_f32 v34, v34
    v_exp_f32 v35, v35
    v_exp_f32 v36, v36
    v_exp_f32 v37, v37
    v_exp_f32 v38, v38
    v_exp_f32 v39, v39
    v_exp_f32 v40, v40
    v_exp_f32 v41, v41
    v_smfmac_f32_32x32x32_bf16 v[56:71], v[120:123], v[32:39], v6
    v_exp_f32 v42, v42
    v_exp_f32 v43, v43
    v_exp_f32 v44, v44
    s_waitcnt vmcnt(12)
    v_mfma_f32_32x32x16_bf16 v[24:39], v[124:127], v[16:19], 0
    v_exp_f32 v45, v45
    v_exp_f32 v46, v46
    v_exp_f32 v47, v47
    v_exp_f32 v48, v48
    v_exp_f32 v49, v49
    v_smfmac_f32_32x32x32_bf16 v[72:87], v[116:119], v[40:47], v6
    ds_read_b64_tr_b16 v[192:193], v8 offset:0
    ds_read_b64_tr_b16 v[194:195], v8 offset:1024
    ds_read_b64_tr_b16 v[248:249], v9 offset:0
    ds_read_b64_tr_b16 v[250:251], v9 offset:1024
    s_add_u32 m0, s79, 87040
    s_add_u32 s77, s83, 172032
    s_mov_b64 exec, s[90:91]
    buffer_load_dwordx4 v3, s[24:27], s77 offen lds
    s_mov_b64 exec, -1
    v_exp_f32 v50, v50
    v_exp_f32 v51, v51
    v_exp_f32 v52, v52
    v_exp_f32 v53, v53
    v_exp_f32 v54, v54
    v_exp_f32 v55, v55
    v_exp_f32 v24, v24
    v_exp_f32 v25, v25
    v_smfmac_f32_32x32x32_bf16 v[72:87], v[120:123], v[48:55], v6
    buffer_load_dwordx4 v[112:115], v4, s[36:39], s74 offen offset:0
    s_mov_b64 exec, s[88:89]
    buffer_load_dwordx4 v[116:119], v5, s[36:39], s81 offen offset:1024
    buffer_load_dwordx4 v[120:123], v5, s[36:39], s81 offen offset:1536
    s_mov_b64 exec, -1
    v_exp_f32 v26, v26
    v_exp_f32 v27, v27
    v_exp_f32 v28, v28
    v_mfma_f32_32x32x16_bf16 v[40:55], v[124:127], v[20:23], 0
    v_exp_f32 v29, v29
    v_exp_f32 v30, v30
    v_exp_f32 v31, v31
    v_exp_f32 v32, v32
    v_exp_f32 v33, v33
    s_waitcnt vmcnt(14)
    v_smfmac_f32_32x32x32_bf16 v[56:71], v[128:131], v[24:31], v6
    ds_read_b64_tr_b16 v[196:197], v8 offset:2048
    ds_read_b64_tr_b16 v[198:199], v8 offset:3072
    ds_read_b64_tr_b16 v[252:253], v9 offset:2048
    ds_read_b64_tr_b16 v[254:255], v9 offset:3072
    s_add_u32 m0, s79, 94208
    s_add_u32 s77, s83, 229376
    s_mov_b64 exec, s[90:91]
    buffer_load_dwordx4 v3, s[24:27], s77 offen lds
    s_mov_b64 exec, -1
    v_exp_f32 v34, v34
    v_exp_f32 v35, v35
    v_exp_f32 v36, v36
    v_exp_f32 v37, v37
    v_exp_f32 v38, v38
    v_exp_f32 v39, v39
    v_exp_f32 v40, v40
    v_exp_f32 v41, v41
    v_smfmac_f32_32x32x32_bf16 v[56:71], v[132:135], v[32:39], v6
    v_exp_f32 v42, v42
    v_exp_f32 v43, v43
    v_exp_f32 v44, v44
    s_waitcnt vmcnt(14)
    v_mfma_f32_32x32x16_bf16 v[24:39], v[88:91], v[16:19], 0
    v_exp_f32 v45, v45
    v_exp_f32 v46, v46
    v_exp_f32 v47, v47
    v_exp_f32 v48, v48
    v_exp_f32 v49, v49
    v_smfmac_f32_32x32x32_bf16 v[72:87], v[128:131], v[40:47], v6
    s_add_u32 m0, s79, 101376
    s_add_u32 s77, s83, 286720
    s_mov_b64 exec, s[90:91]
    buffer_load_dwordx4 v3, s[24:27], s77 offen lds
    s_mov_b64 exec, -1
    v_exp_f32 v50, v50
    v_exp_f32 v51, v51
    v_exp_f32 v52, v52
    v_exp_f32 v53, v53
    v_exp_f32 v54, v54
    v_exp_f32 v55, v55
    v_exp_f32 v24, v24
    v_exp_f32 v25, v25
    v_smfmac_f32_32x32x32_bf16 v[72:87], v[132:135], v[48:55], v6
    buffer_load_dwordx4 v[124:127], v4, s[36:39], s74 offen offset:2048
    s_add_u32 s74, s74, 4096
    s_mov_b64 exec, s[88:89]
    buffer_load_dwordx4 v[128:131], v5, s[36:39], s81 offen offset:3072
    buffer_load_dwordx4 v[132:135], v5, s[36:39], s81 offen offset:3584
    s_mov_b64 exec, -1
    s_add_u32 s81, s81, 4096
    v_exp_f32 v26, v26
    v_exp_f32 v27, v27
    v_exp_f32 v28, v28
    v_mfma_f32_32x32x16_bf16 v[40:55], v[88:91], v[20:23], 0
    v_exp_f32 v29, v29
    v_exp_f32 v30, v30
    v_exp_f32 v31, v31
    v_exp_f32 v32, v32
    v_exp_f32 v33, v33
    s_waitcnt vmcnt(16)
    v_smfmac_f32_32x32x32_bf16 v[56:71], v[92:95], v[24:31], v6
    s_waitcnt lgkmcnt(0)
    s_add_u32 m0, s85, 0
    s_add_u32 s77, s84, 0
    buffer_load_dwordx4 v2, s[20:23], s77 offen lds
    v_exp_f32 v34, v34
    v_exp_f32 v35, v35
    v_exp_f32 v36, v36
    v_exp_f32 v37, v37
    v_exp_f32 v38, v38
    v_exp_f32 v39, v39
    v_exp_f32 v40, v40
    v_exp_f32 v41, v41
    v_smfmac_f32_32x32x32_bf16 v[56:71], v[96:99], v[32:39], v6
    v_exp_f32 v42, v42
    v_exp_f32 v43, v43
    v_exp_f32 v44, v44
    s_waitcnt vmcnt(14)
    v_mfma_f32_32x32x16_bf16 v[24:39], v[100:103], v[16:19], 0
    v_exp_f32 v45, v45
    v_exp_f32 v46, v46
    v_exp_f32 v47, v47
    v_exp_f32 v48, v48
    v_exp_f32 v49, v49
    v_smfmac_f32_32x32x32_bf16 v[72:87], v[92:95], v[40:47], v6
    s_add_u32 m0, s85, 1024
    s_add_u32 s77, s84, 8192
    buffer_load_dwordx4 v2, s[20:23], s77 offen lds
    v_exp_f32 v50, v50
    v_exp_f32 v51, v51
    v_exp_f32 v52, v52
    v_exp_f32 v53, v53
    v_exp_f32 v54, v54
    v_exp_f32 v55, v55
    v_exp_f32 v24, v24
    v_exp_f32 v25, v25
    v_smfmac_f32_32x32x32_bf16 v[72:87], v[96:99], v[48:55], v6
    buffer_load_dwordx4 v[88:91], v4, s[36:39], s74 offen offset:0
    s_mov_b64 exec, s[88:89]
    buffer_load_dwordx4 v[92:95], v5, s[36:39], s81 offen offset:1024
    buffer_load_dwordx4 v[96:99], v5, s[36:39], s81 offen offset:1536
    s_mov_b64 exec, -1
    v_exp_f32 v26, v26
    v_exp_f32 v27, v27
    v_exp_f32 v28, v28
    v_mfma_f32_32x32x16_bf16 v[40:55], v[100:103], v[20:23], 0
    v_exp_f32 v29, v29
    v_exp_f32 v30, v30
    v_exp_f32 v31, v31
    v_exp_f32 v32, v32
    v_exp_f32 v33, v33
    s_waitcnt vmcnt(16)
    v_smfmac_f32_32x32x32_bf16 v[56:71], v[104:107], v[24:31], v6
    s_add_u32 m0, s85, 2048
    s_add_u32 s77, s84, 16384
    buffer_load_dwordx4 v2, s[20:23], s77 offen lds
    v_exp_f32 v34, v34
    v_exp_f32 v35, v35
    v_exp_f32 v36, v36
    v_exp_f32 v37, v37
    v_exp_f32 v38, v38
    v_exp_f32 v39, v39
    v_exp_f32 v40, v40
    v_exp_f32 v41, v41
    v_smfmac_f32_32x32x32_bf16 v[56:71], v[108:111], v[32:39], v6
    v_exp_f32 v42, v42
    v_exp_f32 v43, v43
    v_exp_f32 v44, v44
    s_waitcnt vmcnt(13)
    v_mfma_f32_32x32x16_bf16 v[24:39], v[112:115], v[16:19], 0
    v_exp_f32 v45, v45
    v_exp_f32 v46, v46
    v_exp_f32 v47, v47
    v_exp_f32 v48, v48
    v_exp_f32 v49, v49
    v_smfmac_f32_32x32x32_bf16 v[72:87], v[104:107], v[40:47], v6
    s_add_u32 m0, s85, 3072
    s_add_u32 s77, s84, 24576
    buffer_load_dwordx4 v2, s[20:23], s77 offen lds
    v_exp_f32 v50, v50
    v_exp_f32 v51, v51
    v_exp_f32 v52, v52
    v_exp_f32 v53, v53
    v_exp_f32 v54, v54
    v_exp_f32 v55, v55
    v_exp_f32 v24, v24
    v_exp_f32 v25, v25
    v_smfmac_f32_32x32x32_bf16 v[72:87], v[108:111], v[48:55], v6
    buffer_load_dwordx4 v[100:103], v4, s[36:39], s74 offen offset:2048
    s_add_u32 s74, s74, 4096
    s_mov_b64 exec, s[88:89]
    buffer_load_dwordx4 v[104:107], v5, s[36:39], s81 offen offset:3072
    buffer_load_dwordx4 v[108:111], v5, s[36:39], s81 offen offset:3584
    s_mov_b64 exec, -1
    s_add_u32 s81, s81, 4096
    v_exp_f32 v26, v26
    v_exp_f32 v27, v27
    v_exp_f32 v28, v28
    v_mfma_f32_32x32x16_bf16 v[40:55], v[112:115], v[20:23], 0
    v_exp_f32 v29, v29
    v_exp_f32 v30, v30
    v_exp_f32 v31, v31
    v_exp_f32 v32, v32
    v_exp_f32 v33, v33
    s_waitcnt vmcnt(15)
    v_smfmac_f32_32x32x32_bf16 v[56:71], v[116:119], v[24:31], v6
    s_add_u32 m0, s85, 4096
    s_add_u32 s77, s84, 32768
    buffer_load_dwordx4 v2, s[20:23], s77 offen lds
    v_exp_f32 v34, v34
    v_exp_f32 v35, v35
    v_exp_f32 v36, v36
    v_exp_f32 v37, v37
    v_exp_f32 v38, v38
    v_exp_f32 v39, v39
    v_exp_f32 v40, v40
    v_exp_f32 v41, v41
    v_smfmac_f32_32x32x32_bf16 v[56:71], v[120:123], v[32:39], v6
    v_exp_f32 v42, v42
    v_exp_f32 v43, v43
    v_exp_f32 v44, v44
    s_waitcnt vmcnt(13)
    v_mfma_f32_32x32x16_bf16 v[24:39], v[124:127], v[16:19], 0
    v_exp_f32 v45, v45
    v_exp_f32 v46, v46
    v_exp_f32 v47, v47
    v_exp_f32 v48, v48
    v_exp_f32 v49, v49
    v_smfmac_f32_32x32x32_bf16 v[72:87], v[116:119], v[40:47], v6
    s_add_u32 m0, s85, 5120
    s_add_u32 s77, s84, 40960
    buffer_load_dwordx4 v2, s[20:23], s77 offen lds
    v_exp_f32 v50, v50
    v_exp_f32 v51, v51
    v_exp_f32 v52, v52
    v_exp_f32 v53, v53
    v_exp_f32 v54, v54
    v_exp_f32 v55, v55
    v_exp_f32 v24, v24
    v_exp_f32 v25, v25
    v_smfmac_f32_32x32x32_bf16 v[72:87], v[120:123], v[48:55], v6
    buffer_load_dwordx4 v[112:115], v4, s[36:39], s74 offen offset:0
    s_mov_b64 exec, s[88:89]
    buffer_load_dwordx4 v[116:119], v5, s[36:39], s81 offen offset:1024
    buffer_load_dwordx4 v[120:123], v5, s[36:39], s81 offen offset:1536
    s_mov_b64 exec, -1
    v_exp_f32 v26, v26
    v_exp_f32 v27, v27
    v_exp_f32 v28, v28
    v_mfma_f32_32x32x16_bf16 v[40:55], v[124:127], v[20:23], 0
    v_exp_f32 v29, v29
    v_exp_f32 v30, v30
    v_exp_f32 v31, v31
    v_exp_f32 v32, v32
    v_exp_f32 v33, v33
    s_waitcnt vmcnt(15)
    v_smfmac_f32_32x32x32_bf16 v[56:71], v[128:131], v[24:31], v6
    s_add_u32 m0, s85, 6144
    s_add_u32 s77, s84, 49152
    buffer_load_dwordx4 v2, s[20:23], s77 offen lds
    v_exp_f32 v34, v34
    v_exp_f32 v35, v35
    v_exp_f32 v36, v36
    v_exp_f32 v37, v37
    v_exp_f32 v38, v38
    v_exp_f32 v39, v39
    v_exp_f32 v40, v40
    v_exp_f32 v41, v41
    v_smfmac_f32_32x32x32_bf16 v[56:71], v[132:135], v[32:39], v6
    v_exp_f32 v42, v42
    v_exp_f32 v43, v43
    v_exp_f32 v44, v44
    s_waitcnt vmcnt(13)
    v_mfma_f32_32x32x16_bf16 v[24:39], v[88:91], v[16:19], 0
    v_exp_f32 v45, v45
    v_exp_f32 v46, v46
    v_exp_f32 v47, v47
    v_exp_f32 v48, v48
    v_exp_f32 v49, v49
    v_smfmac_f32_32x32x32_bf16 v[72:87], v[128:131], v[40:47], v6
    s_add_u32 m0, s85, 7168
    s_add_u32 s77, s84, 57344
    buffer_load_dwordx4 v2, s[20:23], s77 offen lds
    v_exp_f32 v50, v50
    v_exp_f32 v51, v51
    v_exp_f32 v52, v52
    v_exp_f32 v53, v53
    v_exp_f32 v54, v54
    v_exp_f32 v55, v55
    s_setprio 1
    v_exp_f32 v24, v24
    v_exp_f32 v25, v25
    v_smfmac_f32_32x32x32_bf16 v[72:87], v[132:135], v[48:55], v6
    buffer_load_dwordx4 v[124:127], v4, s[36:39], s74 offen offset:2048
    s_add_u32 s74, s74, 4096
    s_mov_b64 exec, s[88:89]
    buffer_load_dwordx4 v[128:131], v5, s[36:39], s81 offen offset:3072
    buffer_load_dwordx4 v[132:135], v5, s[36:39], s81 offen offset:3584
    s_mov_b64 exec, -1
    s_add_u32 s81, s81, 4096
    v_exp_f32 v26, v26
    v_exp_f32 v27, v27
    v_exp_f32 v28, v28
    v_mfma_f32_32x32x16_bf16 v[40:55], v[88:91], v[20:23], 0
    v_exp_f32 v29, v29
    v_exp_f32 v30, v30
    v_exp_f32 v31, v31
    v_exp_f32 v32, v32
    v_exp_f32 v33, v33
    s_waitcnt vmcnt(15)
    v_smfmac_f32_32x32x32_bf16 v[56:71], v[92:95], v[24:31], v6
    s_add_u32 m0, s79, 108544
    s_add_u32 s77, s83, 344064
    s_mov_b64 exec, s[90:91]
    buffer_load_dwordx4 v3, s[24:27], s77 offen lds
    s_mov_b64 exec, -1
    v_exp_f32 v34, v34
    v_exp_f32 v35, v35
    v_exp_f32 v36, v36
    v_exp_f32 v37, v37
    v_exp_f32 v38, v38
    v_exp_f32 v39, v39
    v_exp_f32 v40, v40
    v_exp_f32 v41, v41
    v_smfmac_f32_32x32x32_bf16 v[56:71], v[96:99], v[32:39], v6
    v_exp_f32 v42, v42
    v_exp_f32 v43, v43
    v_exp_f32 v44, v44
    s_waitcnt vmcnt(13)
    v_mfma_f32_32x32x16_bf16 v[24:39], v[100:103], v[16:19], 0
    v_exp_f32 v45, v45
    v_exp_f32 v46, v46
    v_exp_f32 v47, v47
    v_exp_f32 v48, v48
    v_exp_f32 v49, v49
    v_smfmac_f32_32x32x32_bf16 v[72:87], v[92:95], v[40:47], v6
    s_add_u32 m0, s79, 115712
    s_add_u32 s77, s83, 401408
    s_mov_b64 exec, s[90:91]
    buffer_load_dwordx4 v3, s[24:27], s77 offen lds
    s_mov_b64 exec, -1
    v_exp_f32 v50, v50
    v_exp_f32 v51, v51
    v_exp_f32 v52, v52
    v_exp_f32 v53, v53
    v_exp_f32 v54, v54
    v_exp_f32 v55, v55
    v_exp_f32 v24, v24
    v_exp_f32 v25, v25
    v_smfmac_f32_32x32x32_bf16 v[72:87], v[96:99], v[48:55], v6
    v_exp_f32 v26, v26
    v_exp_f32 v27, v27
    v_exp_f32 v28, v28
    v_mfma_f32_32x32x16_bf16 v[40:55], v[100:103], v[20:23], 0
    v_exp_f32 v29, v29
    v_exp_f32 v30, v30
    v_exp_f32 v31, v31
    v_exp_f32 v32, v32
    v_exp_f32 v33, v33
    s_waitcnt vmcnt(12)
    v_smfmac_f32_32x32x32_bf16 v[56:71], v[104:107], v[24:31], v6
    s_add_u32 m0, s79, 122880
    s_add_u32 s77, s83, 458752
    s_mov_b64 exec, s[90:91]
    buffer_load_dwordx4 v3, s[24:27], s77 offen lds
    s_mov_b64 exec, -1
    v_exp_f32 v34, v34
    v_exp_f32 v35, v35
    v_exp_f32 v36, v36
    v_exp_f32 v37, v37
    v_exp_f32 v38, v38
    v_exp_f32 v39, v39
    v_exp_f32 v40, v40
    v_exp_f32 v41, v41
    v_smfmac_f32_32x32x32_bf16 v[56:71], v[108:111], v[32:39], v6
    v_exp_f32 v42, v42
    v_exp_f32 v43, v43
    v_exp_f32 v44, v44
    s_waitcnt vmcnt(10)
    v_mfma_f32_32x32x16_bf16 v[24:39], v[112:115], v[16:19], 0
    v_exp_f32 v45, v45
    v_exp_f32 v46, v46
    v_exp_f32 v47, v47
    v_exp_f32 v48, v48
    v_exp_f32 v49, v49
    v_smfmac_f32_32x32x32_bf16 v[72:87], v[104:107], v[40:47], v6
    s_add_u32 m0, s79, 130048
    s_add_u32 s77, s83, 516096
    s_mov_b64 exec, s[90:91]
    buffer_load_dwordx4 v3, s[24:27], s77 offen lds
    s_mov_b64 exec, -1
    v_exp_f32 v50, v50
    v_exp_f32 v51, v51
    v_exp_f32 v52, v52
    v_exp_f32 v53, v53
    v_exp_f32 v54, v54
    v_exp_f32 v55, v55
    v_exp_f32 v24, v24
    v_exp_f32 v25, v25
    v_smfmac_f32_32x32x32_bf16 v[72:87], v[108:111], v[48:55], v6
    v_exp_f32 v26, v26
    v_exp_f32 v27, v27
    v_exp_f32 v28, v28
    v_mfma_f32_32x32x16_bf16 v[40:55], v[112:115], v[20:23], 0
    v_exp_f32 v29, v29
    v_exp_f32 v30, v30
    v_exp_f32 v31, v31
    v_exp_f32 v32, v32
    v_exp_f32 v33, v33
    s_waitcnt vmcnt(9)
    v_smfmac_f32_32x32x32_bf16 v[56:71], v[116:119], v[24:31], v6
    s_mul_i32 s76, s62, 229376
    s_mul_i32 s77, s63, 14336
    s_add_u32 s76, s76, s77
    s_lshl_b32 s77, s64, 11
    s_add_u32 s76, s76, s77
    s_add_u32 s76, s76, 4456448
    s_mul_i32 s76, s76, s70
    s_mul_i32 s77, s70, 114688
    s_lshl_b32 s78, s70, 3
    v_lshrrev_b32 v11, 5, v0
    v_mul_lo_u32 v11, v11, s77
    v_and_b32 v10, 0xf0, v1
    v_mad_u32_u24 v11, v10, s78, v11
    s_mov_b64 exec, s[88:89]
    buffer_load_dword v2, v11, s[36:39], s76 offen
    s_mov_b64 exec, -1
    v_exp_f32 v34, v34
    v_exp_f32 v35, v35
    v_exp_f32 v36, v36
    v_exp_f32 v37, v37
    v_exp_f32 v38, v38
    v_exp_f32 v39, v39
    v_exp_f32 v40, v40
    v_exp_f32 v41, v41
    v_smfmac_f32_32x32x32_bf16 v[56:71], v[120:123], v[32:39], v6
    v_exp_f32 v42, v42
    v_exp_f32 v43, v43
    v_exp_f32 v44, v44
    s_waitcnt vmcnt(7)
    v_mfma_f32_32x32x16_bf16 v[24:39], v[124:127], v[16:19], 0
    v_exp_f32 v45, v45
    v_exp_f32 v46, v46
    v_exp_f32 v47, v47
    v_exp_f32 v48, v48
    v_exp_f32 v49, v49
    v_smfmac_f32_32x32x32_bf16 v[72:87], v[116:119], v[40:47], v6
    v_exp_f32 v50, v50
    v_exp_f32 v51, v51
    v_exp_f32 v52, v52
    v_exp_f32 v53, v53
    v_exp_f32 v54, v54
    v_exp_f32 v55, v55
    s_setprio 0
    v_exp_f32 v24, v24
    v_exp_f32 v25, v25
    v_smfmac_f32_32x32x32_bf16 v[72:87], v[120:123], v[48:55], v6
    v_exp_f32 v26, v26
    v_exp_f32 v27, v27
    v_exp_f32 v28, v28
    v_mfma_f32_32x32x16_bf16 v[40:55], v[124:127], v[20:23], 0
    v_exp_f32 v29, v29
    v_exp_f32 v30, v30
    v_exp_f32 v31, v31
    v_exp_f32 v32, v32
    v_exp_f32 v33, v33
    s_waitcnt vmcnt(5)
    v_smfmac_f32_32x32x32_bf16 v[56:71], v[128:131], v[24:31], v6
    v_exp_f32 v34, v34
    v_exp_f32 v35, v35
    v_exp_f32 v36, v36
    v_exp_f32 v37, v37
    v_exp_f32 v38, v38
    v_exp_f32 v39, v39
    v_exp_f32 v40, v40
    v_exp_f32 v41, v41
    v_smfmac_f32_32x32x32_bf16 v[56:71], v[132:135], v[32:39], v6
    v_exp_f32 v42, v42
    v_exp_f32 v43, v43
    v_exp_f32 v44, v44
    v_exp_f32 v45, v45
    v_exp_f32 v46, v46
    v_exp_f32 v47, v47
    v_exp_f32 v48, v48
    v_exp_f32 v49, v49
    v_smfmac_f32_32x32x32_bf16 v[72:87], v[128:131], v[40:47], v6
    v_exp_f32 v50, v50
    v_exp_f32 v51, v51
    v_exp_f32 v52, v52
    v_exp_f32 v53, v53
    v_exp_f32 v54, v54
    v_exp_f32 v55, v55
    s_nop 1
    v_smfmac_f32_32x32x32_bf16 v[72:87], v[132:135], v[48:55], v6
    s_mov_b32 s75, 0
L_attn_done:
    s_and_b32 s76, s64, 3
    s_mul_i32 s76, s76, 2304
    s_lshl_b32 s77, s67, 14
    s_add_u32 s76, s76, s77
    s_add_u32 s76, s76, 137216
    v_add_u32 v10, s76, v1
    v_lshl_add_u32 v12, v0, 2, s76
    v_xor_b32 v11, 0x4000, v10
    v_xor_b32 v13, 0x4000, v12
    s_nop 2
    ds_write_b128 v10, v[72:75] offset:0
    ds_write_b128 v10, v[76:79] offset:1024
    ds_write_b32 v12, v80 offset:2048
    s_waitcnt vmcnt(5)
    s_waitcnt lgkmcnt(0)
    s_barrier
    ds_read_b32 v32, v13 offset:2048
    ds_read_b128 v[24:27], v11 offset:0
    ds_read_b128 v[28:31], v11 offset:1024
    s_lshl_b32 s78, s64, 2
    s_add_u32 s78, s78, 163328
    v_mov_b32 v13, s78
    v_and_b32 v11, 28, v12
    v_add_u32 v11, 163328, v11
    s_waitcnt lgkmcnt(2)
    v_add_f32 v33, v32, v64
    v_rcp_f32 v32, v33
    s_waitcnt lgkmcnt(0)
    v_pk_add_f32 v[24:25], v[24:25], v[56:57]
    v_pk_add_f32 v[26:27], v[26:27], v[58:59]
    v_pk_add_f32 v[28:29], v[28:29], v[60:61]
    v_pk_add_f32 v[30:31], v[30:31], v[62:63]
    v_mul_f32 v24, v32, v24
    v_mul_f32 v25, v32, v25
    v_mul_f32 v26, v32, v26
    v_mul_f32 v27, v32, v27
    v_mul_f32 v28, v32, v28
    v_mul_f32 v29, v32, v29
    v_mul_f32 v30, v32, v30
    v_mul_f32 v31, v32, v31
    v_cvt_pk_bf16_f32 v80, v24, v25
    v_cvt_pk_bf16_f32 v81, v26, v27
    v_cvt_pk_bf16_f32 v82, v28, v29
    v_cvt_pk_bf16_f32 v83, v30, v31
    s_cmp_eq_u32 s70, 0
    s_cbranch_scc1 L_slow_3
    buffer_store_dwordx4 v[80:83], v1, s[36:39], s41 offen
    s_branch L_join_4
L_slow_3:
    buffer_store_dwordx4 v[80:83], v1, s[36:39], s41 offen sc1
L_join_4:
    s_setprio 0
    v_pk_add_f32 v[24:25], v[24:25], v[26:27]
    v_pk_add_f32 v[28:29], v[28:29], v[30:31]
    v_cmp_nge_f32 vcc, 0x5d800000, v33
    s_nop 0
    s_mov_b64 s[92:93], vcc
    v_pk_add_f32 v[24:25], v[24:25], v[28:29]
    v_cmp_nle_f32 vcc, 0x21800000, v33
    s_nop 0
    s_or_b64 s[92:93], s[92:93], vcc
    v_add_f32 v24, v24, v25
    v_mul_f32 v24, 0, v24
    v_cmp_u_f32 vcc, v24, v24
    s_nop 0
    s_or_b64 s[92:93], s[92:93], vcc
    s_cselect_b32 s77, 1, 0
    s_andn2_b32 s77, s77, s75
    v_mov_b32 v14, s77
    ds_write_b32 v13, v14
    s_cmp_lg_u32 s2, 0
    s_cbranch_scc1 L_noepoch
    s_cmp_lg_u32 s64, 0
    s_cbranch_scc1 L_noepoch
    s_mov_b64 exec, 1
    buffer_store_dword v7, off, s[36:39], 0
    s_mov_b64 exec, -1
L_noepoch:
    s_waitcnt lgkmcnt(0)
    s_barrier
    ds_read_b32 v14, v11
    v_bfe_u32 v12, v0, 2, 1
    v_lshlrev_b32 v12, 7, v12
    v_and_b32 v13, 3, v0
    v_lshl_add_u32 v12, v13, 3, v12
    s_lshl_b32 s76, s65, 13
    v_subrev_u32 v10, s76, v8
    v_subrev_u32 v11, s76, v9
    s_lshl_b32 s76, s62, 10
    s_lshl_b32 s77, s68, 8
    s_add_u32 s76, s76, s77
    s_lshl_b32 s77, s65, 2
    s_add_u32 s76, s76, s77
    s_add_u32 s76, s76, 8192
    s_waitcnt lgkmcnt(0)
    v_cmp_ne_u32 vcc, 0, v14
    s_nop 0
    s_cbranch_vccnz L_fallback
    s_waitcnt vmcnt(0)
    s_mov_b64 exec, 1
    s_cmp_eq_u32 s70, 0
    s_cbranch_scc1 L_slow_5
    buffer_store_dword v7, off, s[36:39], s87 offset:0
    s_branch L_join_6
L_slow_5:
    buffer_store_dword v7, off, s[36:39], s87 offset:0 sc1
L_join_6:
    s_mov_b64 exec, -1
    s_add_u32 s87, s87, 0x8000
    buffer_load_dword v14, v12, s[36:39], s76 offen sc1
    s_add_u32 m0, s79, 137216
    s_add_u32 s77, s83, 573440
    s_mov_b64 exec, s[90:91]
    buffer_load_dwordx4 v3, s[24:27], s77 offen lds
    s_mov_b64 exec, -1
    s_add_u32 m0, s79, 144384
    s_add_u32 s77, s83, 630784
    s_mov_b64 exec, s[90:91]
    buffer_load_dwordx4 v3, s[24:27], s77 offen lds
    s_mov_b64 exec, -1
    s_add_u32 m0, s79, 151552
    s_add_u32 s77, s83, 688128
    s_mov_b64 exec, s[90:91]
    buffer_load_dwordx4 v3, s[24:27], s77 offen lds
    s_mov_b64 exec, -1
    ds_read_b64_tr_b16 v[16:17], v10 offset:0
    ds_read_b64_tr_b16 v[18:19], v10 offset:1024
    ds_read_b64_tr_b16 v[48:49], v11 offset:0
    ds_read_b64_tr_b16 v[50:51], v11 offset:1024
    ds_read_b64_tr_b16 v[20:21], v10 offset:2048
    ds_read_b64_tr_b16 v[22:23], v10 offset:3072
    ds_read_b64_tr_b16 v[52:53], v11 offset:2048
    ds_read_b64_tr_b16 v[54:55], v11 offset:3072
    ds_read_b64_tr_b16 v[24:25], v10 offset:4096
    ds_read_b64_tr_b16 v[26:27], v10 offset:5120
    ds_read_b64_tr_b16 v[56:57], v11 offset:4096
    ds_read_b64_tr_b16 v[58:59], v11 offset:5120
    s_waitcnt lgkmcnt(0)
    ds_read_b64_tr_b16 v[28:29], v10 offset:6144
    ds_read_b64_tr_b16 v[30:31], v10 offset:7168
    ds_read_b64_tr_b16 v[60:61], v11 offset:6144
    ds_read_b64_tr_b16 v[62:63], v11 offset:7168
    ds_read_b64_tr_b16 v[32:33], v10 offset:8192
    ds_read_b64_tr_b16 v[34:35], v10 offset:9216
    ds_read_b64_tr_b16 v[64:65], v11 offset:8192
    ds_read_b64_tr_b16 v[66:67], v11 offset:9216
    ds_read_b64_tr_b16 v[36:37], v10 offset:10240
    ds_read_b64_tr_b16 v[38:39], v10 offset:11264
    ds_read_b64_tr_b16 v[68:69], v11 offset:10240
    ds_read_b64_tr_b16 v[70:71], v11 offset:11264
    s_waitcnt lgkmcnt(0)
    ds_read_b64_tr_b16 v[40:41], v10 offset:12288
    ds_read_b64_tr_b16 v[42:43], v10 offset:13312
    ds_read_b64_tr_b16 v[72:73], v11 offset:12288
    ds_read_b64_tr_b16 v[74:75], v11 offset:13312
    ds_read_b64_tr_b16 v[44:45], v10 offset:14336
    ds_read_b64_tr_b16 v[46:47], v10 offset:15360
    ds_read_b64_tr_b16 v[76:77], v11 offset:14336
    ds_read_b64_tr_b16 v[78:79], v11 offset:15360
    s_lshl_b32 s77, s68, 13
    s_add_u32 s77, s77, s3
    s_add_u32 s78, s77, 4096
    v_lshlrev_b32 v112, 16, v136
    v_and_b32 v113, 0xffff0000, v136
    v_lshlrev_b32 v114, 16, v137
    v_and_b32 v115, 0xffff0000, v137
    v_lshlrev_b32 v116, 16, v138
    v_and_b32 v117, 0xffff0000, v138
    v_lshlrev_b32 v118, 16, v139
    v_and_b32 v119, 0xffff0000, v139
    v_mov_b64 v[120:121], 0
    v_mov_b64 v[122:123], 0
    v_mov_b64 v[124:125], 0
    v_mov_b64 v[126:127], 0
    s_waitcnt lgkmcnt(0)
    s_barrier
    s_waitcnt vmcnt(3)
    v_cmp_ne_u32 vcc, s69, v14
    s_nop 0
    s_cbranch_vccz L_seen_8
    s_mov_b32 s74, 65536
L_poll_7:
    buffer_load_dword v14, v12, s[36:39], s76 offen sc1
    s_waitcnt vmcnt(0)
    v_cmp_ne_u32 vcc, s69, v14
    s_nop 0
    s_cbranch_vccz L_seen_8
    s_sub_u32 s74, s74, 1
    s_cbranch_scc0 L_poll_7
L_seen_8:
    buffer_load_dwordx4 v[80:83], v1, s[36:39], s77 offen offset:0 sc1
    buffer_load_dwordx4 v[84:87], v1, s[36:39], s77 offen offset:1024 sc1
    buffer_load_dwordx4 v[88:91], v1, s[36:39], s77 offen offset:2048 sc1
    buffer_load_dwordx4 v[92:95], v1, s[36:39], s77 offen offset:3072 sc1
    buffer_load_dwordx4 v[96:99], v1, s[36:39], s78 offen offset:0 sc1
    buffer_load_dwordx4 v[100:103], v1, s[36:39], s78 offen offset:1024 sc1
    buffer_load_dwordx4 v[104:107], v1, s[36:39], s78 offen offset:2048 sc1
    buffer_load_dwordx4 v[108:111], v1, s[36:39], s78 offen offset:3072 sc1
    s_lshl_b32 s76, s64, 11
    v_add_u32 v10, s76, v1
    v_xor_b32 v11, 4096, v10
    v_xor_b32 v12, 8192, v10
    v_xor_b32 v13, 12288, v10
    v_bfe_u32 v8, v0, 2, 2
    v_lshrrev_b32 v9, 5, v0
    v_lshl_add_u32 v8, v9, 2, v8
    v_mul_u32_u24 v8, 448, v8
    v_bfe_u32 v9, v0, 4, 1
    v_lshl_add_u32 v8, v9, 5, v8
    v_and_b32 v9, 3, v0
    v_lshl_add_u32 v8, v9, 3, v8
    s_min_u32 s76, s64, 6
    s_lshl_b32 s76, s76, 6
    s_add_u32 s76, s76, 65536
    v_add_u32 v8, s76, v8
    v_add_u32 v9, 57344, v8
    s_waitcnt vmcnt(7)
    v_mfma_f32_32x32x16_bf16 v[128:143], v[48:51], v[80:83], 0
    v_mfma_f32_32x32x16_bf16 v[112:127], v[16:19], v[80:83], v[112:127]
    s_waitcnt vmcnt(6)
    v_mfma_f32_32x32x16_bf16 v[128:143], v[52:55], v[84:87], v[128:143]
    v_mfma_f32_32x32x16_bf16 v[112:127], v[20:23], v[84:87], v[112:127]
    s_waitcnt vmcnt(5)
    v_mfma_f32_32x32x16_bf16 v[128:143], v[56:59], v[88:91], v[128:143]
    v_mfma_f32_32x32x16_bf16 v[112:127], v[24:27], v[88:91], v[112:127]
    s_waitcnt vmcnt(4)
    v_mfma_f32_32x32x16_bf16 v[128:143], v[60:63], v[92:95], v[128:143]
    v_mfma_f32_32x32x16_bf16 v[112:127], v[28:31], v[92:95], v[112:127]
    s_waitcnt vmcnt(3)
    v_mfma_f32_32x32x16_bf16 v[128:143], v[64:67], v[96:99], v[128:143]
    v_mfma_f32_32x32x16_bf16 v[112:127], v[32:35], v[96:99], v[112:127]
    s_waitcnt vmcnt(2)
    v_mfma_f32_32x32x16_bf16 v[128:143], v[68:71], v[100:103], v[128:143]
    v_mfma_f32_32x32x16_bf16 v[112:127], v[36:39], v[100:103], v[112:127]
    s_waitcnt vmcnt(1)
    v_mfma_f32_32x32x16_bf16 v[128:143], v[72:75], v[104:107], v[128:143]
    v_mfma_f32_32x32x16_bf16 v[112:127], v[40:43], v[104:107], v[112:127]
    s_waitcnt vmcnt(0)
    v_mfma_f32_32x32x16_bf16 v[128:143], v[76:79], v[108:111], v[128:143]
    v_mfma_f32_32x32x16_bf16 v[112:127], v[44:47], v[108:111], v[112:127]
    s_nop 10
    ds_write_b128 v10, v[128:131] offset:16384
    ds_write_b128 v10, v[132:135] offset:17408
    ds_write_b128 v10, v[136:139] offset:32768
    ds_write_b128 v10, v[140:143] offset:33792
    ds_write_b128 v10, v[120:123] offset:0
    ds_write_b128 v10, v[124:127] offset:1024
    s_waitcnt lgkmcnt(0)
    s_barrier
    ds_read_b128 v[80:83], v11 offset:0
    ds_read_b128 v[84:87], v11 offset:1024
    ds_read_b128 v[88:91], v12 offset:16384
    ds_read_b128 v[92:95], v12 offset:17408
    ds_read_b128 v[96:99], v13 offset:32768
    ds_read_b128 v[100:103], v13 offset:33792
    s_waitcnt lgkmcnt(4)
    v_pk_add_f32 v[112:113], v[112:113], v[80:81]
    v_pk_add_f32 v[114:115], v[114:115], v[82:83]
    v_pk_add_f32 v[116:117], v[116:117], v[84:85]
    v_pk_add_f32 v[118:119], v[118:119], v[86:87]
    s_waitcnt lgkmcnt(2)
    v_pk_add_f32 v[112:113], v[112:113], v[88:89]
    v_pk_add_f32 v[114:115], v[114:115], v[90:91]
    v_pk_add_f32 v[116:117], v[116:117], v[92:93]
    v_pk_add_f32 v[118:119], v[118:119], v[94:95]
    s_waitcnt lgkmcnt(0)
    v_pk_add_f32 v[112:113], v[112:113], v[96:97]
    v_pk_add_f32 v[114:115], v[114:115], v[98:99]
    v_pk_add_f32 v[116:117], v[116:117], v[100:101]
    v_pk_add_f32 v[118:119], v[118:119], v[102:103]
    v_cvt_pk_bf16_f32 v140, v112, v113
    v_cvt_pk_bf16_f32 v141, v114, v115
    v_cvt_pk_bf16_f32 v142, v116, v117
    v_cvt_pk_bf16_f32 v143, v118, v119
    s_cmp_eq_u32 s70, 0
    s_cbranch_scc1 L_slow_9
    buffer_store_dwordx4 v[140:143], v1, s[32:35], s40 offen
    s_branch L_join_10
L_slow_9:
    buffer_store_dwordx4 v[140:143], v1, s[32:35], s40 offen sc1
L_join_10:
    ds_read_b64_tr_b16 v[48:49], v8 offset:0
    ds_read_b64_tr_b16 v[50:51], v8 offset:3584
    ds_read_b64_tr_b16 v[52:53], v8 offset:7168
    ds_read_b64_tr_b16 v[54:55], v8 offset:10752
    ds_read_b64_tr_b16 v[56:57], v8 offset:14336
    ds_read_b64_tr_b16 v[58:59], v8 offset:17920
    ds_read_b64_tr_b16 v[60:61], v8 offset:21504
    ds_read_b64_tr_b16 v[62:63], v8 offset:25088
    ds_read_b64_tr_b16 v[64:65], v8 offset:28672
    ds_read_b64_tr_b16 v[66:67], v8 offset:32256
    v_and_b32 v12, 7, v0
    v_lshlrev_b32 v12, 2, v12
    v_and_b32 v10, 31, v0
    v_lshlrev_b32 v137, 3, v10
    v_add_u32 v137, 159232, v137
    s_lshl_b32 s76, s62, 3
    s_add_u32 s76, s76, s64
    s_lshl_b32 s76, s76, 7
    s_add_u32 s76, s76, 40960
    s_waitcnt vmcnt(0)
    s_mov_b64 exec, 1
    s_cmp_eq_u32 s70, 0
    s_cbranch_scc1 L_slow_11
    buffer_store_dword v7, off, s[36:39], s87 offset:0
    s_branch L_join_12
L_slow_11:
    buffer_store_dword v7, off, s[36:39], s87 offset:0 sc1
L_join_12:
    s_mov_b64 exec, -1
    s_add_u32 s87, s87, 0x8000
    buffer_load_dword v14, v12, s[36:39], s76 offen sc1
    ds_read_b64_tr_b16 v[68:69], v8 offset:35840
    ds_read_b64_tr_b16 v[70:71], v8 offset:39424
    ds_read_b64_tr_b16 v[72:73], v8 offset:43008
    ds_read_b64_tr_b16 v[74:75], v8 offset:46592
    s_waitcnt lgkmcnt(0)
    ds_read_b64_tr_b16 v[76:77], v8 offset:50176
    ds_read_b64_tr_b16 v[78:79], v8 offset:53760
    ds_read_b64_tr_b16 v[80:81], v9 offset:0
    ds_read_b64_tr_b16 v[82:83], v9 offset:3584
    ds_read_b64_tr_b16 v[84:85], v9 offset:7168
    ds_read_b64_tr_b16 v[86:87], v9 offset:10752
    ds_read_b64_tr_b16 v[88:89], v9 offset:14336
    ds_read_b64_tr_b16 v[90:91], v9 offset:17920
    ds_read_b64_tr_b16 v[92:93], v9 offset:21504
    ds_read_b64_tr_b16 v[94:95], v9 offset:25088
    v_bfe_u32 v10, v0, 2, 1
    v_mul_lo_u32 v130, v10, s71
    v_sub_u32 v128, s71, v130
    v_mov_b32 v129, v128
    v_mov_b32 v131, v130
    v_bfe_u32 v10, v0, 3, 1
    v_mul_u32_u24 v10, 0xaaaa, v10
    v_add_u32 v136, 0x4444, v10
    v_mov_b64 v[132:133], 0
    v_mov_b64 v[134:135], 0
    s_waitcnt lgkmcnt(0)
    s_barrier
    s_add_u32 m0, s79, 65536
    s_add_u32 s77, s83, 745472
    s_mov_b64 exec, s[90:91]
    buffer_load_dwordx4 v3, s[24:27], s77 offen lds
    s_mov_b64 exec, -1
    s_add_u32 m0, s79, 72704
    s_add_u32 s77, s83, 802816
    s_mov_b64 exec, s[90:91]
    buffer_load_dwordx4 v3, s[24:27], s77 offen lds
    s_mov_b64 exec, -1
    s_add_u32 m0, s79, 79872
    s_add_u32 s77, s83, 860160
    s_mov_b64 exec, s[90:91]
    buffer_load_dwordx4 v3, s[24:27], s77 offen lds
    s_mov_b64 exec, -1
    s_add_u32 m0, s79, 87040
    s_add_u32 s77, s83, 917504
    s_mov_b64 exec, s[90:91]
    buffer_load_dwordx4 v3, s[24:27], s77 offen lds
    s_mov_b64 exec, -1
    s_add_u32 m0, s79, 94208
    s_add_u32 s77, s83, 974848
    s_mov_b64 exec, s[90:91]
    buffer_load_dwordx4 v3, s[24:27], s77 offen lds
    s_mov_b64 exec, -1
    s_add_u32 m0, s79, 101376
    s_add_u32 s77, s83, 1032192
    s_mov_b64 exec, s[90:91]
    buffer_load_dwordx4 v3, s[24:27], s77 offen lds
    s_mov_b64 exec, -1
    v_smfmac_f32_16x16x64_bf16 v[132:135], v[128:131], v[48:55], v136
    v_smfmac_f32_16x16x64_bf16 v[132:135], v[128:131], v[56:63], v136
    v_smfmac_f32_16x16x64_bf16 v[132:135], v[128:131], v[64:71], v136
    v_smfmac_f32_16x16x64_bf16 v[132:135], v[128:131], v[72:79], v136
    v_smfmac_f32_16x16x64_bf16 v[132:135], v[128:131], v[80:87], v136
    v_smfmac_f32_16x16x64_bf16 v[132:135], v[128:131], v[88:95], v136
    s_waitcnt vmcnt(6)
    v_cmp_ne_u32 vcc, s69, v14
    s_nop 0
    s_cbranch_vccz L_seen_14
    s_mov_b32 s74, 65536
L_poll_13:
    buffer_load_dword v14, v12, s[36:39], s76 offen sc1
    s_waitcnt vmcnt(0)
    v_cmp_ne_u32 vcc, s69, v14
    s_nop 0
    s_cbranch_vccz L_seen_14
    s_sub_u32 s74, s74, 1
    s_cbranch_scc0 L_poll_13
L_seen_14:
    s_lshl_b32 s77, s62, 16
    s_lshl_b32 s78, s64, 12
    s_add_u32 s77, s77, s78
    s_add_u32 s77, s77, 0
    s_mov_b32 m0, s78
    s_cmp_eq_u32 s67, 0
    s_cbranch_scc1 L_hs0
    s_barrier
L_hs0:
    buffer_load_dwordx4 v1, s[32:35], s77 offen sc1 lds
    buffer_load_dwordx4 v1, s[32:35], s77 offen offset:1024 sc1 lds
    buffer_load_dwordx4 v1, s[32:35], s77 offen offset:2048 sc1 lds
    buffer_load_dwordx4 v1, s[32:35], s77 offen offset:3072 sc1 lds
    s_add_u32 s77, s77, 0x8000
    s_add_u32 m0, s78, 0x8000
    s_nop 0
    buffer_load_dwordx4 v1, s[32:35], s77 offen sc1 lds
    buffer_load_dwordx4 v1, s[32:35], s77 offen offset:1024 sc1 lds
    buffer_load_dwordx4 v1, s[32:35], s77 offen offset:2048 sc1 lds
    buffer_load_dwordx4 v1, s[32:35], s77 offen offset:3072 sc1 lds
    s_cmp_lg_u32 s67, 0
    s_cbranch_scc1 L_hs1
    s_barrier
L_hs1:
    v_add_u32 v10, 0, v0
    v_mul_u32_u24 v11, 2341, v10
    v_lshrrev_b32 v11, 16, v11
    v_mul_u32_u24 v11, 3136, v11
    v_lshl_add_u32 v96, v10, 4, v11
    v_mov_b64 v[16:17], 0
    v_mov_b64 v[18:19], 0
    v_mov_b64 v[20:21], 0
    v_mov_b64 v[22:23], 0
    v_mov_b64 v[24:25], 0
    v_mov_b64 v[26:27], 0
    v_mov_b64 v[28:29], 0
    v_mov_b64 v[30:31], 0
    v_add_u32 v10, 64, v0
    v_mul_u32_u24 v11, 2341, v10
    v_lshrrev_b32 v11, 16, v11
    v_mul_u32_u24 v11, 3136, v11
    v_lshl_add_u32 v97, v10, 4, v11
    v_add_u32 v10, 128, v0
    v_mul_u32_u24 v11, 2341, v10
    v_lshrrev_b32 v11, 16, v11
    v_mul_u32_u24 v11, 3136, v11
    v_lshl_add_u32 v98, v10, 4, v11
    v_add_u32 v10, 192, v0
    v_mul_u32_u24 v11, 2341, v10
    v_lshrrev_b32 v11, 16, v11
    v_mul_u32_u24 v11, 3136, v11
    v_lshl_add_u32 v99, v10, 4, v11
    v_add_u32 v10, 256, v0
    v_mul_u32_u24 v11, 2341, v10
    v_lshrrev_b32 v11, 16, v11
    v_mul_u32_u24 v11, 3136, v11
    v_lshl_add_u32 v100, v10, 4, v11
    v_add_u32 v10, 320, v0
    v_mul_u32_u24 v11, 2341, v10
    v_lshrrev_b32 v11, 16, v11
    v_mul_u32_u24 v11, 3136, v11
    v_lshl_add_u32 v101, v10, 4, v11
    v_add_u32 v10, 384, v0
    v_mul_u32_u24 v11, 2341, v10
    v_lshrrev_b32 v11, 16, v11
    v_mul_u32_u24 v11, 3136, v11
    v_lshl_add_u32 v102, v10, 4, v11
    s_waitcnt vmcnt(8)
    s_cmp_lg_u32 s67, 0
    s_cbranch_scc1 L_hs2
    s_waitcnt vmcnt(0)
L_hs2:
    s_barrier
    s_cmp_eq_u32 s64, 7
    s_cbranch_scc1 L_stats
    ds_read_b128 v[96:99], v1 offset:0
    ds_read_b128 v[100:103], v1 offset:32768
    ds_read_b128 v[104:107], v1 offset:1024
    ds_read_b128 v[108:111], v1 offset:33792
    ds_read_b128 v[112:115], v1 offset:2048
    ds_read_b128 v[116:119], v1 offset:34816
    s_mul_i32 s76, s62, 229376
    s_mul_i32 s77, s63, 14336
    s_add_u32 s76, s76, s77
    s_lshl_b32 s77, s64, 11
    s_add_u32 s76, s76, s77
    s_add_u32 s76, s76, 4456448
    s_add_u32 s77, s76, 114688
    s_waitcnt lgkmcnt(4)
    v_mfma_f32_32x32x16_bf16 v[16:31], v[48:51], v[96:99], 0
    ds_read_b128 v[120:123], v1 offset:3072
    ds_read_b128 v[124:127], v1 offset:35840
    v_mfma_f32_32x32x16_bf16 v[32:47], v[48:51], v[100:103], 0
    ds_read_b64_tr_b16 v[48:49], v9 offset:28672
    ds_read_b64_tr_b16 v[50:51], v9 offset:32256
    s_waitcnt lgkmcnt(6)
    v_mfma_f32_32x32x16_bf16 v[16:31], v[52:55], v[104:107], v[16:31]
    ds_read_b128 v[96:99], v1 offset:4096
    ds_read_b128 v[100:103], v1 offset:36864
    v_mfma_f32_32x32x16_bf16 v[32:47], v[52:55], v[108:111], v[32:47]
    v_mov_b64 v[10:11], 0
    v_mov_b64 v[14:15], 0
    ds_read_b64_tr_b16 v[52:53], v8 offset:0
    ds_read_b64_tr_b16 v[54:55], v8 offset:3584
    s_waitcnt lgkmcnt(8)
    v_mfma_f32_32x32x16_bf16 v[16:31], v[56:59], v[112:115], v[16:31]
    ds_read_b128 v[104:107], v1 offset:5120
    ds_read_b128 v[108:111], v1 offset:37888
    v_mfma_f32_32x32x16_bf16 v[32:47], v[56:59], v[116:119], v[32:47]
    ds_read_b64_tr_b16 v[56:57], v8 offset:7168
    ds_read_b64_tr_b16 v[58:59], v8 offset:10752
    s_waitcnt lgkmcnt(10)
    v_mfma_f32_32x32x16_bf16 v[16:31], v[60:63], v[120:123], v[16:31]
    ds_read_b128 v[112:115], v1 offset:6144
    ds_read_b128 v[116:119], v1 offset:38912
    v_mfma_f32_32x32x16_bf16 v[32:47], v[60:63], v[124:127], v[32:47]
    s_waitcnt lgkmcnt(6)
    v_smfmac_f32_16x16x64_bf16 v[132:135], v[128:131], v[48:55], v136
    ds_read_b64_tr_b16 v[60:61], v8 offset:14336
    ds_read_b64_tr_b16 v[62:63], v8 offset:17920
    v_mfma_f32_32x32x16_bf16 v[16:31], v[64:67], v[96:99], v[16:31]
    ds_read_b128 v[120:123], v1 offset:7168
    ds_read_b128 v[124:127], v1 offset:39936
    v_mfma_f32_32x32x16_bf16 v[32:47], v[64:67], v[100:103], v[32:47]
    ds_read_b64_tr_b16 v[64:65], v8 offset:21504
    ds_read_b64_tr_b16 v[66:67], v8 offset:25088
    s_waitcnt lgkmcnt(10)
    v_mfma_f32_32x32x16_bf16 v[16:31], v[68:71], v[104:107], v[16:31]
    ds_read_b128 v[96:99], v1 offset:8192
    ds_read_b128 v[100:103], v1 offset:40960
    v_mfma_f32_32x32x16_bf16 v[32:47], v[68:71], v[108:111], v[32:47]
    s_waitcnt lgkmcnt(6)
    v_smfmac_f32_16x16x64_bf16 v[132:135], v[128:131], v[56:63], v136
    ds_read_b64_tr_b16 v[68:69], v8 offset:28672
    ds_read_b64_tr_b16 v[70:71], v8 offset:32256
    v_mfma_f32_32x32x16_bf16 v[16:31], v[72:75], v[112:115], v[16:31]
    ds_read_b128 v[104:107], v1 offset:9216
    ds_read_b128 v[108:111], v1 offset:41984
    v_mfma_f32_32x32x16_bf16 v[32:47], v[72:75], v[116:119], v[32:47]
    ds_read_b64_tr_b16 v[72:73], v8 offset:35840
    ds_read_b64_tr_b16 v[74:75], v8 offset:39424
    s_waitcnt lgkmcnt(10)
    v_mfma_f32_32x32x16_bf16 v[16:31], v[76:79], v[120:123], v[16:31]
    ds_read_b128 v[112:115], v1 offset:10240
    ds_read_b128 v[116:119], v1 offset:43008
    v_mfma_f32_32x32x16_bf16 v[32:47], v[76:79], v[124:127], v[32:47]
    s_waitcnt lgkmcnt(6)
    v_smfmac_f32_16x16x64_bf16 v[132:135], v[128:131], v[64:71], v136
    v_mfma_f32_32x32x16_bf16 v[16:31], v[80:83], v[96:99], v[16:31]
    ds_read_b128 v[120:123], v1 offset:11264
    ds_read_b128 v[124:127], v1 offset:44032
    v_mfma_f32_32x32x16_bf16 v[32:47], v[80:83], v[100:103], v[32:47]
    s_waitcnt lgkmcnt(6)
    v_mfma_f32_32x32x16_bf16 v[16:31], v[84:87], v[104:107], v[16:31]
    ds_read_b128 v[96:99], v1 offset:12288
    ds_read_b128 v[100:103], v1 offset:45056
    v_mfma_f32_32x32x16_bf16 v[32:47], v[84:87], v[108:111], v[32:47]
    s_waitcnt lgkmcnt(0)
    s_barrier
    v_mfma_f32_32x32x16_bf16 v[16:31], v[88:91], v[112:115], v[16:31]
    ds_read_b128 v[104:107], v1 offset:13312
    ds_read_b128 v[108:111], v1 offset:46080
    v_mfma_f32_32x32x16_bf16 v[32:47], v[88:91], v[116:119], v[32:47]
    ds_read_b64_tr_b16 v[76:77], v8 offset:43008
    ds_read_b64_tr_b16 v[78:79], v8 offset:46592
    ds_read_b64_tr_b16 v[80:81], v8 offset:50176
    ds_read_b64_tr_b16 v[82:83], v8 offset:53760
    v_mfma_f32_32x32x16_bf16 v[16:31], v[92:95], v[120:123], v[16:31]
    ds_read_b128 v[112:115], v1 offset:14336
    ds_read_b128 v[116:119], v1 offset:47104
    v_mfma_f32_32x32x16_bf16 v[32:47], v[92:95], v[124:127], v[32:47]
    ds_read_b64_tr_b16 v[84:85], v9 offset:0
    ds_read_b64_tr_b16 v[86:87], v9 offset:3584
    ds_read_b64_tr_b16 v[88:89], v9 offset:7168
    ds_read_b64_tr_b16 v[90:91], v9 offset:10752
    v_mfma_f32_32x32x16_bf16 v[16:31], v[48:51], v[96:99], v[16:31]
    ds_read_b128 v[120:123], v1 offset:15360
    ds_read_b128 v[124:127], v1 offset:48128
    v_mfma_f32_32x32x16_bf16 v[32:47], v[48:51], v[100:103], v[32:47]
    s_waitcnt lgkmcnt(10)
    v_smfmac_f32_16x16x64_bf16 v[132:135], v[128:131], v[72:79], v136
    ds_read_b64_tr_b16 v[92:93], v9 offset:14336
    ds_read_b64_tr_b16 v[94:95], v9 offset:17920
    ds_read_b64_tr_b16 v[48:49], v9 offset:21504
    ds_read_b64_tr_b16 v[50:51], v9 offset:25088
    v_mfma_f32_32x32x16_bf16 v[16:31], v[52:55], v[104:107], v[16:31]
    ds_read_b128 v[96:99], v1 offset:16384
    ds_read_b128 v[100:103], v1 offset:49152
    v_mfma_f32_32x32x16_bf16 v[32:47], v[52:55], v[108:111], v[32:47]
    s_waitcnt lgkmcnt(10)
    v_smfmac_f32_16x16x64_bf16 v[132:135], v[128:131], v[80:87], v136
    v_mfma_f32_32x32x16_bf16 v[16:31], v[56:59], v[112:115], v[16:31]
    ds_read_b128 v[104:107], v1 offset:17408
    ds_read_b128 v[108:111], v1 offset:50176
    v_mfma_f32_32x32x16_bf16 v[32:47], v[56:59], v[116:119], v[32:47]
    s_waitcnt lgkmcnt(6)
    v_smfmac_f32_16x16x64_bf16 v[132:135], v[128:131], v[88:95], v136
    v_mfma_f32_32x32x16_bf16 v[16:31], v[60:63], v[120:123], v[16:31]
    ds_read_b128 v[112:115], v1 offset:18432
    ds_read_b128 v[116:119], v1 offset:51200
    v_mfma_f32_32x32x16_bf16 v[32:47], v[60:63], v[124:127], v[32:47]
    s_waitcnt lgkmcnt(4)
    v_mfma_f32_32x32x16_bf16 v[16:31], v[64:67], v[96:99], v[16:31]
    ds_read_b128 v[120:123], v1 offset:19456
    ds_read_b128 v[124:127], v1 offset:52224
    v_mfma_f32_32x32x16_bf16 v[32:47], v[64:67], v[100:103], v[32:47]
    s_waitcnt lgkmcnt(4)
    v_mfma_f32_32x32x16_bf16 v[16:31], v[68:71], v[104:107], v[16:31]
    ds_read_b128 v[96:99], v1 offset:20480
    ds_read_b128 v[100:103], v1 offset:53248
    v_mfma_f32_32x32x16_bf16 v[32:47], v[68:71], v[108:111], v[32:47]
    s_waitcnt lgkmcnt(4)
    v_mfma_f32_32x32x16_bf16 v[16:31], v[72:75], v[112:115], v[16:31]
    ds_read_b128 v[104:107], v1 offset:21504
    ds_read_b128 v[108:111], v1 offset:54272
    v_mfma_f32_32x32x16_bf16 v[32:47], v[72:75], v[116:119], v[32:47]
    s_waitcnt lgkmcnt(4)
    v_mfma_f32_32x32x16_bf16 v[16:31], v[76:79], v[120:123], v[16:31]
    ds_read_b128 v[112:115], v1 offset:22528
    ds_read_b128 v[116:119], v1 offset:55296
    v_mfma_f32_32x32x16_bf16 v[32:47], v[76:79], v[124:127], v[32:47]
    s_waitcnt lgkmcnt(4)
    v_mfma_f32_32x32x16_bf16 v[16:31], v[80:83], v[96:99], v[16:31]
    ds_read_b128 v[120:123], v1 offset:23552
    ds_read_b128 v[124:127], v1 offset:56320
    v_mfma_f32_32x32x16_bf16 v[32:47], v[80:83], v[100:103], v[32:47]
    s_waitcnt lgkmcnt(4)
    v_mfma_f32_32x32x16_bf16 v[16:31], v[84:87], v[104:107], v[16:31]
    ds_read_b128 v[96:99], v1 offset:24576
    ds_read_b128 v[100:103], v1 offset:57344
    v_mfma_f32_32x32x16_bf16 v[32:47], v[84:87], v[108:111], v[32:47]
    s_barrier
    ds_read_b32 v2, v137
    ds_read_b32 v3, v137
    ds_read_b32 v4, v137 offset:256
    ds_read_b32 v5, v137 offset:256
    s_waitcnt lgkmcnt(8)
    v_mfma_f32_32x32x16_bf16 v[16:31], v[88:91], v[112:115], v[16:31]
    ds_read_b128 v[104:107], v1 offset:25600
    ds_read_b128 v[108:111], v1 offset:58368
    v_mfma_f32_32x32x16_bf16 v[32:47], v[88:91], v[116:119], v[32:47]
    ds_read_b64_tr_b16 v[52:53], v9 offset:28672
    ds_read_b64_tr_b16 v[54:55], v9 offset:32256
    ds_read_b64_tr_b16 v[56:57], v8 offset:0
    ds_read_b64_tr_b16 v[58:59], v8 offset:3584
    s_waitcnt lgkmcnt(12)
    v_mfma_f32_32x32x16_bf16 v[16:31], v[92:95], v[120:123], v[16:31]
    ds_read_b128 v[112:115], v1 offset:26624
    ds_read_b128 v[116:119], v1 offset:59392
    v_mfma_f32_32x32x16_bf16 v[32:47], v[92:95], v[124:127], v[32:47]
    ds_read_b64_tr_b16 v[60:61], v8 offset:7168
    ds_read_b64_tr_b16 v[62:63], v8 offset:10752
    ds_read_b64_tr_b16 v[64:65], v8 offset:14336
    ds_read_b64_tr_b16 v[66:67], v8 offset:17920
    s_waitcnt lgkmcnt(15)
    v_mfma_f32_32x32x16_bf16 v[16:31], v[48:51], v[96:99], v[16:31]
    ds_read_b128 v[120:123], v1 offset:27648
    ds_read_b128 v[124:127], v1 offset:60416
    v_mfma_f32_32x32x16_bf16 v[32:47], v[48:51], v[100:103], v[32:47]
    s_waitcnt lgkmcnt(10)
    v_smfmac_f32_16x16x64_bf16 v[132:135], v[128:131], v[48:55], v136
    ds_read_b64_tr_b16 v[68:69], v8 offset:21504
    ds_read_b64_tr_b16 v[70:71], v8 offset:25088
    ds_read_b64_tr_b16 v[72:73], v8 offset:28672
    ds_read_b64_tr_b16 v[74:75], v8 offset:32256
    v_mfma_f32_32x32x16_bf16 v[16:31], v[52:55], v[104:107], v[16:31]
    ds_read_b128 v[96:99], v1 offset:28672
    ds_read_b128 v[100:103], v1 offset:61440
    v_mfma_f32_32x32x16_bf16 v[32:47], v[52:55], v[108:111], v[32:47]
    s_waitcnt lgkmcnt(10)
    v_smfmac_f32_16x16x64_bf16 v[132:135], v[128:131], v[56:63], v136
    ds_read_b64_tr_b16 v[76:77], v8 offset:35840
    ds_read_b64_tr_b16 v[78:79], v8 offset:39424
    v_mfma_f32_32x32x16_bf16 v[16:31], v[56:59], v[112:115], v[16:31]
    ds_read_b128 v[104:107], v1 offset:29696
    ds_read_b128 v[108:111], v1 offset:62464
    v_mfma_f32_32x32x16_bf16 v[32:47], v[56:59], v[116:119], v[32:47]
    s_waitcnt lgkmcnt(8)
    v_smfmac_f32_16x16x64_bf16 v[132:135], v[128:131], v[64:71], v136
    v_mfma_f32_32x32x16_bf16 v[16:31], v[60:63], v[120:123], v[16:31]
    ds_read_b128 v[112:115], v1 offset:30720
    ds_read_b128 v[116:119], v1 offset:63488
    v_mfma_f32_32x32x16_bf16 v[32:47], v[60:63], v[124:127], v[32:47]
    s_waitcnt lgkmcnt(4)
    v_smfmac_f32_16x16x64_bf16 v[132:135], v[128:131], v[72:79], v136
    v_mfma_f32_32x32x16_bf16 v[16:31], v[64:67], v[96:99], v[16:31]
    ds_read_b128 v[120:123], v1 offset:31744
    ds_read_b128 v[124:127], v1 offset:64512
    s_waitcnt lgkmcnt(4)
    v_mfma_f32_32x32x16_bf16 v[16:31], v[68:71], v[104:107], v[16:31]
    s_nop 2
    v_cvt_pk_bf16_f32 v12, v132, v132
    v_lshlrev_b32 v133, 16, v12
    v_sub_f32 v132, v132, v133
    v_cvt_pk_bf16_f32 v13, v132, v132
    s_waitcnt lgkmcnt(2)
    v_mfma_f32_32x32x16_bf16 v[16:31], v[72:75], v[112:115], v[16:31]
    v_mfma_f32_32x32x16_bf16 v[16:31], v[12:15], v[2:5], v[16:31]
    s_waitcnt lgkmcnt(0)
    v_mfma_f32_32x32x16_bf16 v[16:31], v[76:79], v[120:123], v[16:31]
    v_mfma_f32_32x32x16_bf16 v[32:47], v[64:67], v[100:103], v[32:47]
    v_mfma_f32_32x32x16_bf16 v[32:47], v[68:71], v[108:111], v[32:47]
    s_nop 9
    v_cvt_pk_bf16_f32 v80, v16, v17
    v_cvt_pk_bf16_f32 v81, v18, v19
    v_cvt_pk_bf16_f32 v82, v20, v21
    v_cvt_pk_bf16_f32 v83, v22, v23
    v_mfma_f32_32x32x16_bf16 v[32:47], v[72:75], v[116:119], v[32:47]
    v_cvt_pk_bf16_f32 v84, v24, v25
    v_cvt_pk_bf16_f32 v85, v26, v27
    v_cvt_pk_bf16_f32 v86, v28, v29
    v_cvt_pk_bf16_f32 v87, v30, v31
    v_mfma_f32_32x32x16_bf16 v[32:47], v[10:13], v[2:5], v[32:47]
    v_pk_max_i16 v80, v80, 0
    v_pk_max_i16 v81, v81, 0
    v_pk_max_i16 v82, v82, 0
    v_pk_max_i16 v83, v83, 0
    v_pk_max_i16 v84, v84, 0
    v_pk_max_i16 v85, v85, 0
    v_pk_max_i16 v86, v86, 0
    v_pk_max_i16 v87, v87, 0
    v_mfma_f32_32x32x16_bf16 v[32:47], v[76:79], v[124:127], v[32:47]
    s_cmp_eq_u32 s70, 0
    s_cbranch_scc1 L_slow_15
    buffer_store_dwordx4 v[80:83], v1, s[36:39], s76 offen offset:0 nt
    buffer_store_dwordx4 v[84:87], v1, s[36:39], s76 offen offset:1024 nt
    s_branch L_join_16
L_slow_15:
    buffer_store_dwordx4 v[80:83], v1, s[36:39], s76 offen offset:0 sc1
    buffer_store_dwordx4 v[84:87], v1, s[36:39], s76 offen offset:1024 sc1
L_join_16:
    s_nop 7
    v_cvt_pk_bf16_f32 v88, v32, v33
    v_cvt_pk_bf16_f32 v89, v34, v35
    v_cvt_pk_bf16_f32 v90, v36, v37
    v_cvt_pk_bf16_f32 v91, v38, v39
    v_cvt_pk_bf16_f32 v92, v40, v41
    v_cvt_pk_bf16_f32 v93, v42, v43
    v_cvt_pk_bf16_f32 v94, v44, v45
    v_cvt_pk_bf16_f32 v95, v46, v47
    v_pk_max_i16 v88, v88, 0
    v_pk_max_i16 v89, v89, 0
    v_pk_max_i16 v90, v90, 0
    v_pk_max_i16 v91, v91, 0
    v_pk_max_i16 v92, v92, 0
    v_pk_max_i16 v93, v93, 0
    v_pk_max_i16 v94, v94, 0
    v_pk_max_i16 v95, v95, 0
    s_cmp_eq_u32 s70, 0
    s_cbranch_scc1 L_slow_17
    buffer_store_dwordx4 v[88:91], v1, s[36:39], s77 offen offset:0 nt
    buffer_store_dwordx4 v[92:95], v1, s[36:39], s77 offen offset:1024 nt
    s_branch L_join_18
L_slow_17:
    buffer_store_dwordx4 v[88:91], v1, s[36:39], s77 offen offset:0 sc1
    buffer_store_dwordx4 v[92:95], v1, s[36:39], s77 offen offset:1024 sc1
L_join_18:
    s_waitcnt vmcnt(0)
    s_mov_b64 exec, 1
    s_cmp_eq_u32 s70, 0
    s_cbranch_scc1 L_slow_19
    buffer_store_dword v7, off, s[36:39], s87 offset:0
    s_branch L_join_20
L_slow_19:
    buffer_store_dword v7, off, s[36:39], s87 offset:0 sc1
L_join_20:
    s_mov_b64 exec, -1
    s_add_u32 s87, s87, 0x8000
    s_nop 1
    s_add_u32 s79, s63, 1
    v_and_b32 v12, 7, v0
    v_min_u32 v12, 5, v12
    v_lshlrev_b32 v12, 2, v12
    s_add_u32 s79, s79, s64
    s_and_b32 s79, s79, 7
    s_lshl_b32 s76, s62, 3
    s_add_u32 s76, s76, s79
    s_lshl_b32 s76, s76, 7
    s_add_u32 s76, s76, 73728
    buffer_load_dword v14, v12, s[36:39], s76 offen sc1
    s_lshl_b32 s77, s65, 8
    v_add_u32 v137, s77, v137
    s_mul_i32 s86, s79, 14336
    s_mul_i32 s77, s62, 229376
    s_add_u32 s77, s77, 4456448
    s_mul_i32 s78, s65, 114688
    s_add_u32 s78, s78, s77
    s_xor_b32 s79, s65, 1
    s_mul_i32 s79, s79, 114688
    s_add_u32 s77, s77, s79
    s_lshl_b32 s79, s64, 11
    v_add_u32 v10, s79, v1
    v_add_u32 v11, 0x10000, v10
    s_cmp_eq_u32 s67, 0
    s_cbranch_scc1 L_ok1
    s_cmp_eq_u32 s65, 0
    s_cbranch_scc1 L_own_21
    v_mfma_f32_32x32x16_bf16 v[32:47], v[248:251], v[80:83], 0
    v_mfma_f32_32x32x16_bf16 v[16:31], v[192:195], v[80:83], 0
    v_mfma_f32_32x32x16_bf16 v[64:79], v[248:251], v[88:91], 0
    v_mfma_f32_32x32x16_bf16 v[48:63], v[192:195], v[88:91], 0
    v_mfma_f32_32x32x16_bf16 v[32:47], v[252:255], v[84:87], v[32:47]
    v_mfma_f32_32x32x16_bf16 v[16:31], v[196:199], v[84:87], v[16:31]
    v_mfma_f32_32x32x16_bf16 v[64:79], v[252:255], v[92:95], v[64:79]
    v_mfma_f32_32x32x16_bf16 v[48:63], v[196:199], v[92:95], v[48:63]
    s_branch L_own_22
L_own_21:
    v_mfma_f32_32x32x16_bf16 v[64:79], v[248:251], v[80:83], 0
    v_mfma_f32_32x32x16_bf16 v[48:63], v[192:195], v[80:83], 0
    v_mfma_f32_32x32x16_bf16 v[32:47], v[248:251], v[88:91], 0
    v_mfma_f32_32x32x16_bf16 v[16:31], v[192:195], v[88:91], 0
    v_mfma_f32_32x32x16_bf16 v[64:79], v[252:255], v[84:87], v[64:79]
    v_mfma_f32_32x32x16_bf16 v[48:63], v[196:199], v[84:87], v[48:63]
    v_mfma_f32_32x32x16_bf16 v[32:47], v[252:255], v[92:95], v[32:47]
    v_mfma_f32_32x32x16_bf16 v[16:31], v[196:199], v[92:95], v[16:31]
L_own_22:
L_ok1:
    s_add_u32 s77, s77, s86
    s_add_u32 s78, s78, s86
    s_cmp_eq_u32 s67, 0
    s_cbranch_scc1 L_gb0
    s_barrier
L_gb0:
    s_waitcnt vmcnt(0)
    v_cmp_ne_u32 vcc, s69, v14
    s_nop 0
    s_cbranch_vccz L_seen_24
    s_mov_b32 s74, 65536
L_poll_23:
    buffer_load_dword v14, v12, s[36:39], s76 offen sc1
    s_waitcnt vmcnt(0)
    v_cmp_ne_u32 vcc, s69, v14
    s_nop 0
    s_cbranch_vccz L_seen_24
    s_sub_u32 s74, s74, 1
    s_cbranch_scc0 L_poll_23
L_seen_24:
    buffer_load_dwordx4 v[96:99], v1, s[36:39], s77 offen offset:0 sc1
    buffer_load_dwordx4 v[100:103], v1, s[36:39], s77 offen offset:1024 sc1
    buffer_load_dwordx4 v[104:107], v1, s[36:39], s77 offen offset:2048 sc1
    buffer_load_dwordx4 v[108:111], v1, s[36:39], s77 offen offset:3072 sc1
    s_add_u32 s77, s77, 4096
    buffer_load_dwordx4 v[112:115], v1, s[36:39], s77 offen offset:0 sc1
    buffer_load_dwordx4 v[116:119], v1, s[36:39], s77 offen offset:1024 sc1
    buffer_load_dwordx4 v[120:123], v1, s[36:39], s77 offen offset:2048 sc1
    buffer_load_dwordx4 v[124:127], v1, s[36:39], s77 offen offset:3072 sc1
    s_add_u32 s77, s77, 4096
    buffer_load_dwordx4 v[128:131], v1, s[36:39], s77 offen offset:0 sc1
    buffer_load_dwordx4 v[132:135], v1, s[36:39], s77 offen offset:1024 sc1
    s_cmp_lg_u32 s67, 0
    s_cbranch_scc1 L_gb1
    s_cmp_eq_u32 s65, 0
    s_cbranch_scc1 L_own_25
    v_mfma_f32_32x32x16_bf16 v[32:47], v[248:251], v[80:83], 0
    v_mfma_f32_32x32x16_bf16 v[16:31], v[192:195], v[80:83], 0
    v_mfma_f32_32x32x16_bf16 v[64:79], v[248:251], v[88:91], 0
    v_mfma_f32_32x32x16_bf16 v[48:63], v[192:195], v[88:91], 0
    v_mfma_f32_32x32x16_bf16 v[32:47], v[252:255], v[84:87], v[32:47]
    v_mfma_f32_32x32x16_bf16 v[16:31], v[196:199], v[84:87], v[16:31]
    v_mfma_f32_32x32x16_bf16 v[64:79], v[252:255], v[92:95], v[64:79]
    v_mfma_f32_32x32x16_bf16 v[48:63], v[196:199], v[92:95], v[48:63]
    s_branch L_own_26
L_own_25:
    v_mfma_f32_32x32x16_bf16 v[64:79], v[248:251], v[80:83], 0
    v_mfma_f32_32x32x16_bf16 v[48:63], v[192:195], v[80:83], 0
    v_mfma_f32_32x32x16_bf16 v[32:47], v[248:251], v[88:91], 0
    v_mfma_f32_32x32x16_bf16 v[16:31], v[192:195], v[88:91], 0
    v_mfma_f32_32x32x16_bf16 v[64:79], v[252:255], v[84:87], v[64:79]
    v_mfma_f32_32x32x16_bf16 v[48:63], v[196:199], v[84:87], v[48:63]
    v_mfma_f32_32x32x16_bf16 v[32:47], v[252:255], v[92:95], v[32:47]
    v_mfma_f32_32x32x16_bf16 v[16:31], v[196:199], v[92:95], v[16:31]
L_own_26:
    s_barrier
L_gb1:
    ds_read_b32 v136, v137 offset:4
    s_nop 3
    buffer_load_dwordx4 v[80:83], v1, s[36:39], s77 offen offset:2048 sc1
    buffer_load_dwordx4 v[84:87], v1, s[36:39], s77 offen offset:3072 sc1
    buffer_load_dwordx4 v[88:91], v1, s[36:39], s78 offen offset:0 sc1
    buffer_load_dwordx4 v[92:95], v1, s[36:39], s78 offen offset:1024 sc1
    s_waitcnt vmcnt(13)
    v_mfma_f32_32x32x16_bf16 v[32:47], v[200:203], v[96:99], v[32:47]
    v_mfma_f32_32x32x16_bf16 v[16:31], v[144:147], v[96:99], v[16:31]
    s_waitcnt vmcnt(12)
    v_mfma_f32_32x32x16_bf16 v[32:47], v[204:207], v[100:103], v[32:47]
    v_mfma_f32_32x32x16_bf16 v[16:31], v[148:151], v[100:103], v[16:31]
    buffer_load_dwordx4 v[96:99], v1, s[36:39], s78 offen offset:2048 sc1
    s_waitcnt vmcnt(12)
    v_mfma_f32_32x32x16_bf16 v[32:47], v[208:211], v[104:107], v[32:47]
    v_mfma_f32_32x32x16_bf16 v[16:31], v[152:155], v[104:107], v[16:31]
    buffer_load_dwordx4 v[100:103], v1, s[36:39], s78 offen offset:3072 sc1
    s_waitcnt vmcnt(12)
    v_mfma_f32_32x32x16_bf16 v[32:47], v[212:215], v[108:111], v[32:47]
    v_mfma_f32_32x32x16_bf16 v[16:31], v[156:159], v[108:111], v[16:31]
    s_add_u32 s78, s78, 4096
    buffer_load_dwordx4 v[104:107], v1, s[36:39], s78 offen offset:0 sc1
    s_waitcnt vmcnt(12)
    v_mfma_f32_32x32x16_bf16 v[32:47], v[216:219], v[112:115], v[32:47]
    v_mfma_f32_32x32x16_bf16 v[16:31], v[160:163], v[112:115], v[16:31]
    buffer_load_dwordx4 v[108:111], v1, s[36:39], s78 offen offset:1024 sc1
    s_waitcnt vmcnt(12)
    v_mfma_f32_32x32x16_bf16 v[32:47], v[220:223], v[116:119], v[32:47]
    v_mfma_f32_32x32x16_bf16 v[16:31], v[164:167], v[116:119], v[16:31]
    buffer_load_dwordx4 v[112:115], v1, s[36:39], s78 offen offset:2048 sc1
    s_waitcnt vmcnt(12)
    v_mfma_f32_32x32x16_bf16 v[32:47], v[224:227], v[120:123], v[32:47]
    v_mfma_f32_32x32x16_bf16 v[16:31], v[168:171], v[120:123], v[16:31]
    buffer_load_dwordx4 v[116:119], v1, s[36:39], s78 offen offset:3072 sc1
    s_waitcnt vmcnt(12)
    v_mfma_f32_32x32x16_bf16 v[32:47], v[228:231], v[124:127], v[32:47]
    v_mfma_f32_32x32x16_bf16 v[16:31], v[172:175], v[124:127], v[16:31]
    s_add_u32 s78, s78, 4096
    buffer_load_dwordx4 v[120:123], v1, s[36:39], s78 offen offset:0 sc1
    s_waitcnt vmcnt(12)
    v_mfma_f32_32x32x16_bf16 v[32:47], v[232:235], v[128:131], v[32:47]
    v_mfma_f32_32x32x16_bf16 v[16:31], v[176:179], v[128:131], v[16:31]
    buffer_load_dwordx4 v[124:127], v1, s[36:39], s78 offen offset:1024 sc1
    s_waitcnt vmcnt(12)
    v_mfma_f32_32x32x16_bf16 v[32:47], v[236:239], v[132:135], v[32:47]
    v_mfma_f32_32x32x16_bf16 v[16:31], v[180:183], v[132:135], v[16:31]
    buffer_load_dwordx4 v[128:131], v1, s[36:39], s78 offen offset:2048 sc1
    s_waitcnt vmcnt(12)
    v_mfma_f32_32x32x16_bf16 v[32:47], v[240:243], v[80:83], v[32:47]
    v_mfma_f32_32x32x16_bf16 v[16:31], v[184:187], v[80:83], v[16:31]
    buffer_load_dwordx4 v[132:135], v1, s[36:39], s78 offen offset:3072 sc1
    s_waitcnt vmcnt(12)
    v_mfma_f32_32x32x16_bf16 v[32:47], v[244:247], v[84:87], v[32:47]
    v_mfma_f32_32x32x16_bf16 v[16:31], v[188:191], v[84:87], v[16:31]
    s_waitcnt vmcnt(11)
    v_mfma_f32_32x32x16_bf16 v[64:79], v[200:203], v[88:91], v[64:79]
    v_mfma_f32_32x32x16_bf16 v[48:63], v[144:147], v[88:91], v[48:63]
    s_waitcnt vmcnt(10)
    v_mfma_f32_32x32x16_bf16 v[64:79], v[204:207], v[92:95], v[64:79]
    v_mfma_f32_32x32x16_bf16 v[48:63], v[148:151], v[92:95], v[48:63]
    s_waitcnt vmcnt(9)
    v_mfma_f32_32x32x16_bf16 v[64:79], v[208:211], v[96:99], v[64:79]
    v_mfma_f32_32x32x16_bf16 v[48:63], v[152:155], v[96:99], v[48:63]
    s_nop 1
    ds_write_b128 v11, v[32:35] offset:0
    ds_write_b128 v11, v[36:39] offset:1024
    s_waitcnt vmcnt(8)
    v_mfma_f32_32x32x16_bf16 v[64:79], v[212:215], v[100:103], v[64:79]
    v_mfma_f32_32x32x16_bf16 v[48:63], v[156:159], v[100:103], v[48:63]
    s_waitcnt vmcnt(7)
    v_mfma_f32_32x32x16_bf16 v[64:79], v[216:219], v[104:107], v[64:79]
    v_mfma_f32_32x32x16_bf16 v[48:63], v[160:163], v[104:107], v[48:63]
    ds_write_b128 v11, v[40:43] offset:32768
    ds_write_b128 v11, v[44:47] offset:33792
    s_waitcnt vmcnt(6)
    v_mfma_f32_32x32x16_bf16 v[64:79], v[220:223], v[108:111], v[64:79]
    v_mfma_f32_32x32x16_bf16 v[48:63], v[164:167], v[108:111], v[48:63]
    s_waitcnt vmcnt(5)
    v_mfma_f32_32x32x16_bf16 v[64:79], v[224:227], v[112:115], v[64:79]
    v_mfma_f32_32x32x16_bf16 v[48:63], v[168:171], v[112:115], v[48:63]
    ds_write_b128 v10, v[16:19] offset:0
    ds_write_b128 v10, v[20:23] offset:1024
    s_waitcnt vmcnt(4)
    v_mfma_f32_32x32x16_bf16 v[64:79], v[228:231], v[116:119], v[64:79]
    v_mfma_f32_32x32x16_bf16 v[48:63], v[172:175], v[116:119], v[48:63]
    s_waitcnt vmcnt(3)
    v_mfma_f32_32x32x16_bf16 v[64:79], v[232:235], v[120:123], v[64:79]
    v_mfma_f32_32x32x16_bf16 v[48:63], v[176:179], v[120:123], v[48:63]
    ds_write_b128 v10, v[24:27] offset:32768
    ds_write_b128 v10, v[28:31] offset:33792
    s_waitcnt vmcnt(2)
    v_mfma_f32_32x32x16_bf16 v[64:79], v[236:239], v[124:127], v[64:79]
    v_mfma_f32_32x32x16_bf16 v[48:63], v[180:183], v[124:127], v[48:63]
    s_waitcnt vmcnt(1)
    v_mfma_f32_32x32x16_bf16 v[64:79], v[240:243], v[128:131], v[64:79]
    v_mfma_f32_32x32x16_bf16 v[48:63], v[184:187], v[128:131], v[48:63]
    s_waitcnt vmcnt(0)
    v_mfma_f32_32x32x16_bf16 v[64:79], v[244:247], v[132:135], v[64:79]
    v_mfma_f32_32x32x16_bf16 v[48:63], v[188:191], v[132:135], v[48:63]
L_ffn2_done:
    v_and_b32 v12, 31, v0
    v_lshlrev_b32 v12, 10, v12
    v_lshrrev_b32 v13, 5, v0
    v_lshl_add_u32 v12, v13, 4, v12
    s_lshl_b32 s76, s63, 7
    s_lshl_b32 s77, s68, 5
    s_add_u32 s76, s76, s77
    s_add_u32 s76, s76, s80
    s_nop 2
    ds_write_b128 v10, v[64:67] offset:49152
    ds_write_b128 v10, v[68:71] offset:50176
    ds_write_b128 v11, v[72:75] offset:16384
    ds_write_b128 v11, v[76:79] offset:17408
    ds_write_b128 v10, v[56:59] offset:16384
    ds_write_b128 v10, v[60:63] offset:17408
    s_waitcnt lgkmcnt(0)
    s_barrier
    v_xor_b32 v13, 2048, v10
    ds_read_b128 v[80:83], v13 offset:0
    ds_read_b128 v[84:87], v13 offset:1024
    v_xor_b32 v13, 20480, v10
    ds_read_b128 v[88:91], v13 offset:0
    ds_read_b128 v[92:95], v13 offset:1024
    v_xor_b32 v13, 38912, v10
    ds_read_b128 v[96:99], v13 offset:0
    ds_read_b128 v[100:103], v13 offset:1024
    v_xor_b32 v13, 57344, v10
    ds_read_b128 v[104:107], v13 offset:0
    ds_read_b128 v[108:111], v13 offset:1024
    v_xor_b32 v13, 75776, v10
    ds_read_b128 v[112:115], v13 offset:0
    ds_read_b128 v[116:119], v13 offset:1024
    v_xor_b32 v13, 94208, v10
    ds_read_b128 v[120:123], v13 offset:0
    ds_read_b128 v[124:127], v13 offset:1024
    v_xor_b32 v13, 112640, v10
    ds_read_b128 v[128:131], v13 offset:0
    ds_read_b128 v[132:135], v13 offset:1024
    v_lshlrev_b32 v16, 16, v140
    v_and_b32 v17, 0xffff0000, v140
    v_lshlrev_b32 v18, 16, v141
    v_and_b32 v19, 0xffff0000, v141
    v_lshlrev_b32 v20, 16, v142
    v_and_b32 v21, 0xffff0000, v142
    v_lshlrev_b32 v22, 16, v143
    v_and_b32 v23, 0xffff0000, v143
    s_waitcnt lgkmcnt(12)
    v_pk_add_f32 v[48:49], v[48:49], v[80:81]
    v_pk_add_f32 v[50:51], v[50:51], v[82:83]
    v_pk_add_f32 v[52:53], v[52:53], v[84:85]
    v_pk_add_f32 v[54:55], v[54:55], v[86:87]
    s_waitcnt lgkmcnt(10)
    v_pk_add_f32 v[48:49], v[48:49], v[88:89]
    v_pk_add_f32 v[50:51], v[50:51], v[90:91]
    v_pk_add_f32 v[52:53], v[52:53], v[92:93]
    v_pk_add_f32 v[54:55], v[54:55], v[94:95]
    s_waitcnt lgkmcnt(8)
    v_pk_add_f32 v[48:49], v[48:49], v[96:97]
    v_pk_add_f32 v[50:51], v[50:51], v[98:99]
    v_pk_add_f32 v[52:53], v[52:53], v[100:101]
    v_pk_add_f32 v[54:55], v[54:55], v[102:103]
    s_waitcnt lgkmcnt(6)
    v_pk_add_f32 v[48:49], v[48:49], v[104:105]
    v_pk_add_f32 v[50:51], v[50:51], v[106:107]
    v_pk_add_f32 v[52:53], v[52:53], v[108:109]
    v_pk_add_f32 v[54:55], v[54:55], v[110:111]
    s_waitcnt lgkmcnt(4)
    v_pk_add_f32 v[48:49], v[48:49], v[112:113]
    v_pk_add_f32 v[50:51], v[50:51], v[114:115]
    v_pk_add_f32 v[52:53], v[52:53], v[116:117]
    v_pk_add_f32 v[54:55], v[54:55], v[118:119]
    s_waitcnt lgkmcnt(2)
    v_pk_add_f32 v[48:49], v[48:49], v[120:121]
    v_pk_add_f32 v[50:51], v[50:51], v[122:123]
    v_pk_add_f32 v[52:53], v[52:53], v[124:125]
    v_pk_add_f32 v[54:55], v[54:55], v[126:127]
    s_waitcnt lgkmcnt(0)
    v_pk_add_f32 v[48:49], v[48:49], v[128:129]
    v_pk_add_f32 v[50:51], v[50:51], v[130:131]
    v_pk_add_f32 v[52:53], v[52:53], v[132:133]
    v_pk_add_f32 v[54:55], v[54:55], v[134:135]
    v_fma_f32 v48, v136, v48, v16
    v_fma_f32 v49, v136, v49, v17
    v_fma_f32 v50, v136, v50, v18
    v_fma_f32 v51, v136, v51, v19
    v_fma_f32 v52, v136, v52, v20
    v_fma_f32 v53, v136, v53, v21
    v_fma_f32 v54, v136, v54, v22
    v_fma_f32 v55, v136, v55, v23
    v_cvt_pk_bf16_f32 v16, v48, v49
    v_cvt_pk_bf16_f32 v17, v50, v51
    v_cvt_pk_bf16_f32 v18, v52, v53
    v_cvt_pk_bf16_f32 v19, v54, v55
    s_nop 0
    v_permlane32_swap_b32 v16, v18
    v_permlane32_swap_b32 v17, v19
    buffer_store_dwordx4 v[16:19], v12, s[32:35], s76 offen
    s_endpgm
L_stats:
    s_setprio 3
    ds_read_b128 v[48:51], v1 offset:0
    ds_read_b128 v[52:55], v1 offset:1024
    ds_read_b128 v[56:59], v1 offset:2048
    ds_read_b128 v[60:63], v1 offset:3072
    ds_read_b128 v[64:67], v1 offset:4096
    ds_read_b128 v[68:71], v1 offset:5120
    ds_read_b128 v[72:75], v1 offset:6144
    ds_read_b128 v[76:79], v1 offset:7168
    s_mov_b32 m0, 108544
    s_add_u32 s77, s83, 1089536
    buffer_load_dwordx4 v96, s[24:27], s77 offen lds
    s_mov_b32 m0, 109568
    s_nop 0
    buffer_load_dwordx4 v97, s[24:27], s77 offen lds
    ds_read_b128 v[80:83], v1 offset:8192
    s_mov_b32 m0, 110592
    s_nop 0
    buffer_load_dwordx4 v98, s[24:27], s77 offen lds
    s_waitcnt lgkmcnt(7)
    v_smfmac_f32_16x16x64_bf16 v[16:19], v[128:131], v[48:55], v136
    ds_read_b128 v[84:87], v1 offset:9216
    s_mov_b32 m0, 111616
    s_nop 0
    buffer_load_dwordx4 v99, s[24:27], s77 offen lds
    ds_read_b128 v[88:91], v1 offset:10240
    s_mov_b32 m0, 112640
    s_nop 0
    buffer_load_dwordx4 v100, s[24:27], s77 offen lds
    s_mov_b32 m0, 113664
    s_nop 0
    buffer_load_dwordx4 v101, s[24:27], s77 offen lds
    s_waitcnt lgkmcnt(7)
    v_smfmac_f32_16x16x64_bf16 v[16:19], v[128:131], v[56:63], v136
    ds_read_b128 v[92:95], v1 offset:11264
    s_mov_b32 m0, 114688
    s_nop 0
    buffer_load_dwordx4 v102, s[24:27], s77 offen lds
    ds_read_b128 v[48:51], v1 offset:12288
    s_mov_b32 m0, 115712
    s_add_u32 s77, s83, 1146880
    buffer_load_dwordx4 v96, s[24:27], s77 offen lds
    s_waitcnt lgkmcnt(7)
    v_smfmac_f32_16x16x64_bf16 v[16:19], v[128:131], v[64:71], v136
    ds_read_b128 v[52:55], v1 offset:13312
    s_mov_b32 m0, 116736
    s_nop 0
    buffer_load_dwordx4 v97, s[24:27], s77 offen lds
    s_mov_b32 m0, 117760
    s_nop 0
    buffer_load_dwordx4 v98, s[24:27], s77 offen lds
    ds_read_b128 v[56:59], v1 offset:14336
    s_mov_b32 m0, 118784
    s_nop 0
    buffer_load_dwordx4 v99, s[24:27], s77 offen lds
    s_waitcnt lgkmcnt(7)
    v_smfmac_f32_16x16x64_bf16 v[16:19], v[128:131], v[72:79], v136
    ds_read_b128 v[60:63], v1 offset:15360
    s_mov_b32 m0, 119808
    s_nop 0
    buffer_load_dwordx4 v100, s[24:27], s77 offen lds
    ds_read_b128 v[64:67], v1 offset:32768
    s_mov_b32 m0, 120832
    s_nop 0
    buffer_load_dwordx4 v101, s[24:27], s77 offen lds
    s_mov_b32 m0, 121856
    s_nop 0
    buffer_load_dwordx4 v102, s[24:27], s77 offen lds
    s_waitcnt lgkmcnt(7)
    v_smfmac_f32_16x16x64_bf16 v[16:19], v[128:131], v[80:87], v136
    ds_read_b128 v[68:71], v1 offset:33792
    s_mov_b32 m0, 122880
    s_add_u32 s77, s83, 1204224
    buffer_load_dwordx4 v96, s[24:27], s77 offen lds
    ds_read_b128 v[72:75], v1 offset:34816
    s_mov_b32 m0, 123904
    s_nop 0
    buffer_load_dwordx4 v97, s[24:27], s77 offen lds
    s_waitcnt lgkmcnt(7)
    v_smfmac_f32_16x16x64_bf16 v[16:19], v[128:131], v[88:95], v136
    ds_read_b128 v[76:79], v1 offset:35840
    s_mov_b32 m0, 124928
    s_nop 0
    buffer_load_dwordx4 v98, s[24:27], s77 offen lds
    s_mov_b32 m0, 125952
    s_nop 0
    buffer_load_dwordx4 v99, s[24:27], s77 offen lds
    ds_read_b128 v[80:83], v1 offset:36864
    s_mov_b32 m0, 126976
    s_nop 0
    buffer_load_dwordx4 v100, s[24:27], s77 offen lds
    s_waitcnt lgkmcnt(7)
    v_smfmac_f32_16x16x64_bf16 v[16:19], v[128:131], v[48:55], v136
    ds_read_b128 v[84:87], v1 offset:37888
    s_mov_b32 m0, 128000
    s_nop 0
    buffer_load_dwordx4 v101, s[24:27], s77 offen lds
    ds_read_b128 v[88:91], v1 offset:38912
    s_mov_b32 m0, 129024
    s_nop 0
    buffer_load_dwordx4 v102, s[24:27], s77 offen lds
    s_waitcnt lgkmcnt(7)
    v_smfmac_f32_16x16x64_bf16 v[16:19], v[128:131], v[56:63], v136
    ds_read_b128 v[92:95], v1 offset:39936
    s_mov_b32 m0, 130048
    s_add_u32 s77, s83, 1261568
    buffer_load_dwordx4 v96, s[24:27], s77 offen lds
    s_mov_b32 m0, 131072
    s_nop 0
    buffer_load_dwordx4 v97, s[24:27], s77 offen lds
    ds_read_b128 v[48:51], v1 offset:40960
    s_mov_b32 m0, 132096
    s_nop 0
    buffer_load_dwordx4 v98, s[24:27], s77 offen lds
    s_waitcnt lgkmcnt(7)
    v_smfmac_f32_16x16x64_bf16 v[20:23], v[128:131], v[64:71], v136
    ds_read_b128 v[52:55], v1 offset:41984
    s_mov_b32 m0, 133120
    s_nop 0
    buffer_load_dwordx4 v99, s[24:27], s77 offen lds
    ds_read_b128 v[56:59], v1 offset:43008
    s_mov_b32 m0, 134144
    s_nop 0
    buffer_load_dwordx4 v100, s[24:27], s77 offen lds
    s_mov_b32 m0, 135168
    s_nop 0
    buffer_load_dwordx4 v101, s[24:27], s77 offen lds
    s_waitcnt lgkmcnt(7)
    v_smfmac_f32_16x16x64_bf16 v[20:23], v[128:131], v[72:79], v136
    ds_read_b128 v[60:63], v1 offset:44032
    s_mov_b32 m0, 136192
    s_nop 0
    buffer_load_dwordx4 v102, s[24:27], s77 offen lds
    ds_read_b128 v[64:67], v1 offset:45056
    s_mov_b32 m0, 137216
    s_add_u32 s77, s83, 1318912
    buffer_load_dwordx4 v96, s[24:27], s77 offen lds
    s_waitcnt lgkmcnt(7)
    v_smfmac_f32_16x16x64_bf16 v[20:23], v[128:131], v[80:87], v136
    ds_read_b128 v[68:71], v1 offset:46080
    s_mov_b32 m0, 138240
    s_nop 0
    buffer_load_dwordx4 v97, s[24:27], s77 offen lds
    s_mov_b32 m0, 139264
    s_nop 0
    buffer_load_dwordx4 v98, s[24:27], s77 offen lds
    ds_read_b128 v[72:75], v1 offset:47104
    s_mov_b32 m0, 140288
    s_nop 0
    buffer_load_dwordx4 v99, s[24:27], s77 offen lds
    s_waitcnt lgkmcnt(7)
    v_smfmac_f32_16x16x64_bf16 v[20:23], v[128:131], v[88:95], v136
    ds_read_b128 v[76:79], v1 offset:48128
    s_mov_b32 m0, 141312
    s_nop 0
    buffer_load_dwordx4 v100, s[24:27], s77 offen lds
    s_mov_b32 m0, 142336
    s_nop 0
    buffer_load_dwordx4 v101, s[24:27], s77 offen lds
    s_mov_b32 m0, 143360
    s_nop 0
    buffer_load_dwordx4 v102, s[24:27], s77 offen lds
    s_waitcnt lgkmcnt(6)
    v_smfmac_f32_16x16x64_bf16 v[20:23], v[128:131], v[48:55], v136
    s_mov_b32 m0, 144384
    s_add_u32 s77, s83, 1376256
    buffer_load_dwordx4 v96, s[24:27], s77 offen lds
    s_mov_b32 m0, 145408
    s_nop 0
    buffer_load_dwordx4 v97, s[24:27], s77 offen lds
    s_waitcnt lgkmcnt(4)
    v_smfmac_f32_16x16x64_bf16 v[20:23], v[128:131], v[56:63], v136
    s_mov_b32 m0, 146432
    s_nop 0
    buffer_load_dwordx4 v98, s[24:27], s77 offen lds
    s_mov_b32 m0, 147456
    s_nop 0
    buffer_load_dwordx4 v99, s[24:27], s77 offen lds
    s_mov_b32 m0, 148480
    s_nop 0
    buffer_load_dwordx4 v100, s[24:27], s77 offen lds
    s_waitcnt lgkmcnt(2)
    v_smfmac_f32_16x16x64_bf16 v[20:23], v[128:131], v[64:71], v136
    s_mov_b32 m0, 149504
    s_nop 0
    buffer_load_dwordx4 v101, s[24:27], s77 offen lds
    s_mov_b32 m0, 150528
    s_nop 0
    buffer_load_dwordx4 v102, s[24:27], s77 offen lds
    s_waitcnt lgkmcnt(0)
    v_smfmac_f32_16x16x64_bf16 v[20:23], v[128:131], v[72:79], v136
    s_waitcnt vmcnt(0)
    s_barrier
    ds_read_b128 v[80:83], v1 offset:16384
    ds_read_b128 v[84:87], v1 offset:17408
    ds_read_b128 v[88:91], v1 offset:18432
    ds_read_b128 v[92:95], v1 offset:19456
    ds_read_b128 v[48:51], v1 offset:20480
    ds_read_b128 v[52:55], v1 offset:21504
    ds_read_b128 v[56:59], v1 offset:22528
    ds_read_b128 v[60:63], v1 offset:23552
    s_mov_b32 m0, 151552
    s_add_u32 s77, s83, 1433600
    buffer_load_dwordx4 v96, s[24:27], s77 offen lds
    s_mov_b32 m0, 152576
    s_nop 0
    buffer_load_dwordx4 v97, s[24:27], s77 offen lds
    ds_read_b128 v[64:67], v1 offset:24576
    s_mov_b32 m0, 153600
    s_nop 0
    buffer_load_dwordx4 v98, s[24:27], s77 offen lds
    s_waitcnt lgkmcnt(7)
    v_smfmac_f32_16x16x64_bf16 v[16:19], v[128:131], v[80:87], v136
    ds_read_b128 v[68:71], v1 offset:25600
    s_mov_b32 m0, 154624
    s_nop 0
    buffer_load_dwordx4 v99, s[24:27], s77 offen lds
    s_mov_b32 m0, 155648
    s_nop 0
    buffer_load_dwordx4 v100, s[24:27], s77 offen lds
    ds_read_b128 v[72:75], v1 offset:26624
    s_mov_b32 m0, 156672
    s_nop 0
    buffer_load_dwordx4 v101, s[24:27], s77 offen lds
    s_waitcnt lgkmcnt(7)
    v_smfmac_f32_16x16x64_bf16 v[16:19], v[128:131], v[88:95], v136
    ds_read_b128 v[76:79], v1 offset:27648
    s_mov_b32 m0, 157696
    s_nop 0
    buffer_load_dwordx4 v102, s[24:27], s77 offen lds
    s_mov_b32 m0, 65536
    s_add_u32 s77, s83, 1490944
    buffer_load_dwordx4 v96, s[24:27], s77 offen lds
    ds_read_b128 v[80:83], v1 offset:28672
    s_mov_b32 m0, 66560
    s_nop 0
    buffer_load_dwordx4 v97, s[24:27], s77 offen lds
    s_waitcnt lgkmcnt(7)
    v_smfmac_f32_16x16x64_bf16 v[16:19], v[128:131], v[48:55], v136
    ds_read_b128 v[84:87], v1 offset:29696
    s_mov_b32 m0, 67584
    s_nop 0
    buffer_load_dwordx4 v98, s[24:27], s77 offen lds
    s_mov_b32 m0, 68608
    s_nop 0
    buffer_load_dwordx4 v99, s[24:27], s77 offen lds
    ds_read_b128 v[88:91], v1 offset:30720
    s_mov_b32 m0, 69632
    s_nop 0
    buffer_load_dwordx4 v100, s[24:27], s77 offen lds
    s_waitcnt lgkmcnt(7)
    v_smfmac_f32_16x16x64_bf16 v[16:19], v[128:131], v[56:63], v136
    ds_read_b128 v[92:95], v1 offset:31744
    s_mov_b32 m0, 70656
    s_nop 0
    buffer_load_dwordx4 v101, s[24:27], s77 offen lds
    ds_read_b128 v[48:51], v1 offset:49152
    s_mov_b32 m0, 71680
    s_nop 0
    buffer_load_dwordx4 v102, s[24:27], s77 offen lds
    s_mov_b32 m0, 72704
    s_add_u32 s77, s83, 1548288
    buffer_load_dwordx4 v96, s[24:27], s77 offen lds
    s_waitcnt lgkmcnt(7)
    v_smfmac_f32_16x16x64_bf16 v[16:19], v[128:131], v[64:71], v136
    ds_read_b128 v[52:55], v1 offset:50176
    s_mov_b32 m0, 73728
    s_nop 0
    buffer_load_dwordx4 v97, s[24:27], s77 offen lds
    ds_read_b128 v[56:59], v1 offset:51200
    s_mov_b32 m0, 74752
    s_nop 0
    buffer_load_dwordx4 v98, s[24:27], s77 offen lds
    s_mov_b32 m0, 75776
    s_nop 0
    buffer_load_dwordx4 v99, s[24:27], s77 offen lds
    s_waitcnt lgkmcnt(7)
    v_smfmac_f32_16x16x64_bf16 v[16:19], v[128:131], v[72:79], v136
    ds_read_b128 v[60:63], v1 offset:52224
    s_mov_b32 m0, 76800
    s_nop 0
    buffer_load_dwordx4 v100, s[24:27], s77 offen lds
    ds_read_b128 v[64:67], v1 offset:53248
    s_mov_b32 m0, 77824
    s_nop 0
    buffer_load_dwordx4 v101, s[24:27], s77 offen lds
    s_mov_b32 m0, 78848
    s_nop 0
    buffer_load_dwordx4 v102, s[24:27], s77 offen lds
    s_waitcnt lgkmcnt(7)
    v_smfmac_f32_16x16x64_bf16 v[16:19], v[128:131], v[80:87], v136
    ds_read_b128 v[68:71], v1 offset:54272
    s_mov_b32 m0, 79872
    s_add_u32 s77, s83, 1605632
    buffer_load_dwordx4 v96, s[24:27], s77 offen lds
    ds_read_b128 v[72:75], v1 offset:55296
    s_mov_b32 m0, 80896
    s_nop 0
    buffer_load_dwordx4 v97, s[24:27], s77 offen lds
    s_mov_b32 m0, 81920
    s_nop 0
    buffer_load_dwordx4 v98, s[24:27], s77 offen lds
    s_waitcnt lgkmcnt(7)
    v_smfmac_f32_16x16x64_bf16 v[16:19], v[128:131], v[88:95], v136
    ds_read_b128 v[76:79], v1 offset:56320
    s_mov_b32 m0, 82944
    s_nop 0
    buffer_load_dwordx4 v99, s[24:27], s77 offen lds
    ds_read_b128 v[80:83], v1 offset:57344
    s_mov_b32 m0, 83968
    s_nop 0
    buffer_load_dwordx4 v100, s[24:27], s77 offen lds
    s_waitcnt lgkmcnt(7)
    v_smfmac_f32_16x16x64_bf16 v[20:23], v[128:131], v[48:55], v136
    ds_read_b128 v[84:87], v1 offset:58368
    s_mov_b32 m0, 84992
    s_nop 0
    buffer_load_dwordx4 v101, s[24:27], s77 offen lds
    s_mov_b32 m0, 86016
    s_nop 0
    buffer_load_dwordx4 v102, s[24:27], s77 offen lds
    ds_read_b128 v[88:91], v1 offset:59392
    s_mov_b32 m0, 87040
    s_add_u32 s77, s83, 1662976
    buffer_load_dwordx4 v96, s[24:27], s77 offen lds
    s_waitcnt lgkmcnt(7)
    v_smfmac_f32_16x16x64_bf16 v[20:23], v[128:131], v[56:63], v136
    ds_read_b128 v[92:95], v1 offset:60416
    s_mov_b32 m0, 88064
    s_nop 0
    buffer_load_dwordx4 v97, s[24:27], s77 offen lds
    s_mov_b32 m0, 89088
    s_nop 0
    buffer_load_dwordx4 v98, s[24:27], s77 offen lds
    ds_read_b128 v[48:51], v1 offset:61440
    s_mov_b32 m0, 90112
    s_nop 0
    buffer_load_dwordx4 v99, s[24:27], s77 offen lds
    s_waitcnt lgkmcnt(7)
    v_smfmac_f32_16x16x64_bf16 v[20:23], v[128:131], v[64:71], v136
    ds_read_b128 v[52:55], v1 offset:62464
    s_mov_b32 m0, 91136
    s_nop 0
    buffer_load_dwordx4 v100, s[24:27], s77 offen lds
    s_mov_b32 m0, 92160
    s_nop 0
    buffer_load_dwordx4 v101, s[24:27], s77 offen lds
    ds_read_b128 v[56:59], v1 offset:63488
    s_mov_b32 m0, 93184
    s_nop 0
    buffer_load_dwordx4 v102, s[24:27], s77 offen lds
    s_waitcnt lgkmcnt(7)
    v_smfmac_f32_16x16x64_bf16 v[20:23], v[128:131], v[72:79], v136
    ds_read_b128 v[60:63], v1 offset:64512
    s_mov_b32 m0, 94208
    s_add_u32 s77, s83, 1720320
    buffer_load_dwordx4 v96, s[24:27], s77 offen lds
    s_mov_b32 m0, 95232
    s_nop 0
    buffer_load_dwordx4 v97, s[24:27], s77 offen lds
    ds_read_b128 v[64:67], v1 offset:0
    s_mov_b32 m0, 96256
    s_nop 0
    buffer_load_dwordx4 v98, s[24:27], s77 offen lds
    s_waitcnt lgkmcnt(7)
    v_smfmac_f32_16x16x64_bf16 v[20:23], v[128:131], v[80:87], v136
    ds_read_b128 v[68:71], v1 offset:1024
    s_mov_b32 m0, 97280
    s_nop 0
    buffer_load_dwordx4 v99, s[24:27], s77 offen lds
    ds_read_b128 v[72:75], v1 offset:2048
    s_mov_b32 m0, 98304
    s_nop 0
    buffer_load_dwordx4 v100, s[24:27], s77 offen lds
    s_mov_b32 m0, 99328
    s_nop 0
    buffer_load_dwordx4 v101, s[24:27], s77 offen lds
    s_waitcnt lgkmcnt(7)
    v_smfmac_f32_16x16x64_bf16 v[20:23], v[128:131], v[88:95], v136
    ds_read_b128 v[76:79], v1 offset:3072
    s_mov_b32 m0, 100352
    s_nop 0
    buffer_load_dwordx4 v102, s[24:27], s77 offen lds
    ds_read_b128 v[80:83], v1 offset:4096
    s_mov_b32 m0, 101376
    s_add_u32 s77, s83, 1777664
    buffer_load_dwordx4 v96, s[24:27], s77 offen lds
    s_mov_b32 m0, 102400
    s_nop 0
    buffer_load_dwordx4 v97, s[24:27], s77 offen lds
    s_waitcnt lgkmcnt(7)
    v_smfmac_f32_16x16x64_bf16 v[20:23], v[128:131], v[48:55], v136
    ds_read_b128 v[84:87], v1 offset:5120
    s_mov_b32 m0, 103424
    s_nop 0
    buffer_load_dwordx4 v98, s[24:27], s77 offen lds
    ds_read_b128 v[88:91], v1 offset:6144
    s_mov_b32 m0, 104448
    s_nop 0
    buffer_load_dwordx4 v99, s[24:27], s77 offen lds
    s_mov_b32 m0, 105472
    s_nop 0
    buffer_load_dwordx4 v100, s[24:27], s77 offen lds
    s_waitcnt lgkmcnt(7)
    v_smfmac_f32_16x16x64_bf16 v[20:23], v[128:131], v[56:63], v136
    ds_read_b128 v[92:95], v1 offset:7168
    s_mov_b32 m0, 106496
    s_nop 0
    buffer_load_dwordx4 v101, s[24:27], s77 offen lds
    s_waitcnt lgkmcnt(7)
    v_dot2_f32_bf16 v24, v64, v64, v24
    v_dot2_f32_bf16 v25, v65, v65, v25
    v_dot2_f32_bf16 v24, v66, v66, v24
    v_dot2_f32_bf16 v25, v67, v67, v25
    ds_read_b128 v[48:51], v1 offset:8192
    s_mov_b32 m0, 107520
    s_nop 0
    buffer_load_dwordx4 v102, s[24:27], s77 offen lds
    s_waitcnt lgkmcnt(7)
    v_dot2_f32_bf16 v24, v68, v68, v24
    v_dot2_f32_bf16 v25, v69, v69, v25
    v_dot2_f32_bf16 v24, v70, v70, v24
    v_dot2_f32_bf16 v25, v71, v71, v25
    ds_read_b128 v[52:55], v1 offset:9216
    v_mov_b32 v18, v16
    s_nop 1
    v_permlane32_swap_b32 v16, v18
    v_add_f32 v16, v16, v18
    v_mul_f32 v17, 0xbb000000, v16
    v_cvt_pk_bf16_f32 v16, v17, v17
    v_lshlrev_b32 v16, 16, v16
    v_sub_f32 v18, v17, v16
    v_cvt_pk_bf16_f32 v16, v16, v18
    ds_write_b32 v137, v16 offset:0
    v_mov_b32 v22, v20
    s_nop 1
    v_permlane32_swap_b32 v20, v22
    v_add_f32 v20, v20, v22
    v_mul_f32 v21, 0xbb000000, v20
    v_cvt_pk_bf16_f32 v20, v21, v21
    v_lshlrev_b32 v20, 16, v20
    v_sub_f32 v22, v21, v20
    v_cvt_pk_bf16_f32 v20, v20, v22
    ds_write_b32 v137, v20 offset:256
    s_waitcnt vmcnt(0)
    s_waitcnt lgkmcnt(0)
    s_barrier
    v_dot2_f32_bf16 v24, v72, v72, v24
    v_dot2_f32_bf16 v25, v73, v73, v25
    v_dot2_f32_bf16 v24, v74, v74, v24
    v_dot2_f32_bf16 v25, v75, v75, v25
    ds_read_b128 v[56:59], v1 offset:10240
    v_dot2_f32_bf16 v24, v76, v76, v24
    v_dot2_f32_bf16 v25, v77, v77, v25
    v_dot2_f32_bf16 v24, v78, v78, v24
    v_dot2_f32_bf16 v25, v79, v79, v25
    ds_read_b128 v[60:63], v1 offset:11264
    v_dot2_f32_bf16 v24, v80, v80, v24
    v_dot2_f32_bf16 v25, v81, v81, v25
    v_dot2_f32_bf16 v24, v82, v82, v24
    v_dot2_f32_bf16 v25, v83, v83, v25
    ds_read_b128 v[64:67], v1 offset:12288
    v_dot2_f32_bf16 v24, v84, v84, v24
    v_dot2_f32_bf16 v25, v85, v85, v25
    v_dot2_f32_bf16 v24, v86, v86, v24
    v_dot2_f32_bf16 v25, v87, v87, v25
    ds_read_b128 v[68:71], v1 offset:13312
    v_dot2_f32_bf16 v24, v88, v88, v24
    v_dot2_f32_bf16 v25, v89, v89, v25
    v_dot2_f32_bf16 v24, v90, v90, v24
    v_dot2_f32_bf16 v25, v91, v91, v25
    ds_read_b128 v[72:75], v1 offset:14336
    v_dot2_f32_bf16 v24, v92, v92, v24
    v_dot2_f32_bf16 v25, v93, v93, v25
    v_dot2_f32_bf16 v24, v94, v94, v24
    v_dot2_f32_bf16 v25, v95, v95, v25
    ds_read_b128 v[76:79], v1 offset:15360
    v_dot2_f32_bf16 v24, v48, v48, v24
    v_dot2_f32_bf16 v25, v49, v49, v25
    v_dot2_f32_bf16 v24, v50, v50, v24
    v_dot2_f32_bf16 v25, v51, v51, v25
    ds_read_b128 v[80:83], v1 offset:16384
    v_dot2_f32_bf16 v24, v52, v52, v24
    v_dot2_f32_bf16 v25, v53, v53, v25
    v_dot2_f32_bf16 v24, v54, v54, v24
    v_dot2_f32_bf16 v25, v55, v55, v25
    ds_read_b128 v[84:87], v1 offset:17408
    s_waitcnt lgkmcnt(7)
    v_dot2_f32_bf16 v24, v56, v56, v24
    v_dot2_f32_bf16 v25, v57, v57, v25
    v_dot2_f32_bf16 v24, v58, v58, v24
    v_dot2_f32_bf16 v25, v59, v59, v25
    ds_read_b128 v[88:91], v1 offset:18432
    s_waitcnt lgkmcnt(7)
    v_dot2_f32_bf16 v24, v60, v60, v24
    v_dot2_f32_bf16 v25, v61, v61, v25
    v_dot2_f32_bf16 v24, v62, v62, v24
    v_dot2_f32_bf16 v25, v63, v63, v25
    ds_read_b128 v[92:95], v1 offset:19456
    s_waitcnt lgkmcnt(7)
    v_dot2_f32_bf16 v24, v64, v64, v24
    v_dot2_f32_bf16 v25, v65, v65, v25
    v_dot2_f32_bf16 v24, v66, v66, v24
    v_dot2_f32_bf16 v25, v67, v67, v25
    ds_read_b128 v[48:51], v1 offset:20480
    s_waitcnt lgkmcnt(7)
    v_dot2_f32_bf16 v24, v68, v68, v24
    v_dot2_f32_bf16 v25, v69, v69, v25
    v_dot2_f32_bf16 v24, v70, v70, v24
    v_dot2_f32_bf16 v25, v71, v71, v25
    ds_read_b128 v[52:55], v1 offset:21504
    s_waitcnt lgkmcnt(7)
    v_dot2_f32_bf16 v24, v72, v72, v24
    v_dot2_f32_bf16 v25, v73, v73, v25
    v_dot2_f32_bf16 v24, v74, v74, v24
    v_dot2_f32_bf16 v25, v75, v75, v25
    ds_read_b128 v[56:59], v1 offset:22528
    s_waitcnt lgkmcnt(7)
    v_dot2_f32_bf16 v24, v76, v76, v24
    v_dot2_f32_bf16 v25, v77, v77, v25
    v_dot2_f32_bf16 v24, v78, v78, v24
    v_dot2_f32_bf16 v25, v79, v79, v25
    ds_read_b128 v[60:63], v1 offset:23552
    s_waitcnt lgkmcnt(7)
    v_dot2_f32_bf16 v24, v80, v80, v24
    v_dot2_f32_bf16 v25, v81, v81, v25
    v_dot2_f32_bf16 v24, v82, v82, v24
    v_dot2_f32_bf16 v25, v83, v83, v25
    ds_read_b128 v[64:67], v1 offset:24576
    s_waitcnt lgkmcnt(7)
    v_dot2_f32_bf16 v24, v84, v84, v24
    v_dot2_f32_bf16 v25, v85, v85, v25
    v_dot2_f32_bf16 v24, v86, v86, v24
    v_dot2_f32_bf16 v25, v87, v87, v25
    ds_read_b128 v[68:71], v1 offset:25600
    s_waitcnt lgkmcnt(7)
    v_dot2_f32_bf16 v24, v88, v88, v24
    v_dot2_f32_bf16 v25, v89, v89, v25
    v_dot2_f32_bf16 v24, v90, v90, v24
    v_dot2_f32_bf16 v25, v91, v91, v25
    ds_read_b128 v[72:75], v1 offset:26624
    s_waitcnt lgkmcnt(7)
    v_dot2_f32_bf16 v24, v92, v92, v24
    v_dot2_f32_bf16 v25, v93, v93, v25
    v_dot2_f32_bf16 v24, v94, v94, v24
    v_dot2_f32_bf16 v25, v95, v95, v25
    ds_read_b128 v[76:79], v1 offset:27648
    s_waitcnt lgkmcnt(7)
    v_dot2_f32_bf16 v24, v48, v48, v24
    v_dot2_f32_bf16 v25, v49, v49, v25
    v_dot2_f32_bf16 v24, v50, v50, v24
    v_dot2_f32_bf16 v25, v51, v51, v25
    ds_read_b128 v[80:83], v1 offset:28672
    s_waitcnt lgkmcnt(7)
    v_dot2_f32_bf16 v24, v52, v52, v24
    v_dot2_f32_bf16 v25, v53, v53, v25
    v_dot2_f32_bf16 v24, v54, v54, v24
    v_dot2_f32_bf16 v25, v55, v55, v25
    ds_read_b128 v[84:87], v1 offset:29696
    s_waitcnt lgkmcnt(7)
    v_dot2_f32_bf16 v24, v56, v56, v24
    v_dot2_f32_bf16 v25, v57, v57, v25
    v_dot2_f32_bf16 v24, v58, v58, v24
    v_dot2_f32_bf16 v25, v59, v59, v25
    ds_read_b128 v[88:91], v1 offset:30720
    s_waitcnt lgkmcnt(7)
    v_dot2_f32_bf16 v24, v60, v60, v24
    v_dot2_f32_bf16 v25, v61, v61, v25
    v_dot2_f32_bf16 v24, v62, v62, v24
    v_dot2_f32_bf16 v25, v63, v63, v25
    ds_read_b128 v[92:95], v1 offset:31744
    s_waitcnt lgkmcnt(7)
    v_dot2_f32_bf16 v24, v64, v64, v24
    v_dot2_f32_bf16 v25, v65, v65, v25
    v_dot2_f32_bf16 v24, v66, v66, v24
    v_dot2_f32_bf16 v25, v67, v67, v25
    ds_read_b128 v[48:51], v1 offset:32768
    s_waitcnt lgkmcnt(7)
    v_dot2_f32_bf16 v24, v68, v68, v24
    v_dot2_f32_bf16 v25, v69, v69, v25
    v_dot2_f32_bf16 v24, v70, v70, v24
    v_dot2_f32_bf16 v25, v71, v71, v25
    ds_read_b128 v[52:55], v1 offset:33792
    s_waitcnt lgkmcnt(7)
    v_dot2_f32_bf16 v24, v72, v72, v24
    v_dot2_f32_bf16 v25, v73, v73, v25
    v_dot2_f32_bf16 v24, v74, v74, v24
    v_dot2_f32_bf16 v25, v75, v75, v25
    ds_read_b128 v[56:59], v1 offset:34816
    s_waitcnt lgkmcnt(7)
    v_dot2_f32_bf16 v24, v76, v76, v24
    v_dot2_f32_bf16 v25, v77, v77, v25
    v_dot2_f32_bf16 v24, v78, v78, v24
    v_dot2_f32_bf16 v25, v79, v79, v25
    ds_read_b128 v[60:63], v1 offset:35840
    s_waitcnt lgkmcnt(7)
    v_dot2_f32_bf16 v24, v80, v80, v24
    v_dot2_f32_bf16 v25, v81, v81, v25
    v_dot2_f32_bf16 v24, v82, v82, v24
    v_dot2_f32_bf16 v25, v83, v83, v25
    ds_read_b128 v[64:67], v1 offset:36864
    s_waitcnt lgkmcnt(7)
    v_dot2_f32_bf16 v24, v84, v84, v24
    v_dot2_f32_bf16 v25, v85, v85, v25
    v_dot2_f32_bf16 v24, v86, v86, v24
    v_dot2_f32_bf16 v25, v87, v87, v25
    ds_read_b128 v[68:71], v1 offset:37888
    s_waitcnt lgkmcnt(7)
    v_dot2_f32_bf16 v24, v88, v88, v24
    v_dot2_f32_bf16 v25, v89, v89, v25
    v_dot2_f32_bf16 v24, v90, v90, v24
    v_dot2_f32_bf16 v25, v91, v91, v25
    ds_read_b128 v[72:75], v1 offset:38912
    s_waitcnt lgkmcnt(7)
    v_dot2_f32_bf16 v24, v92, v92, v24
    v_dot2_f32_bf16 v25, v93, v93, v25
    v_dot2_f32_bf16 v24, v94, v94, v24
    v_dot2_f32_bf16 v25, v95, v95, v25
    ds_read_b128 v[76:79], v1 offset:39936
    s_waitcnt lgkmcnt(7)
    v_dot2_f32_bf16 v26, v48, v48, v26
    v_dot2_f32_bf16 v27, v49, v49, v27
    v_dot2_f32_bf16 v26, v50, v50, v26
    v_dot2_f32_bf16 v27, v51, v51, v27
    ds_read_b128 v[80:83], v1 offset:40960
    s_waitcnt lgkmcnt(7)
    v_dot2_f32_bf16 v26, v52, v52, v26
    v_dot2_f32_bf16 v27, v53, v53, v27
    v_dot2_f32_bf16 v26, v54, v54, v26
    v_dot2_f32_bf16 v27, v55, v55, v27
    ds_read_b128 v[84:87], v1 offset:41984
    s_waitcnt lgkmcnt(7)
    v_dot2_f32_bf16 v26, v56, v56, v26
    v_dot2_f32_bf16 v27, v57, v57, v27
    v_dot2_f32_bf16 v26, v58, v58, v26
    v_dot2_f32_bf16 v27, v59, v59, v27
    ds_read_b128 v[88:91], v1 offset:43008
    s_waitcnt lgkmcnt(7)
    v_dot2_f32_bf16 v26, v60, v60, v26
    v_dot2_f32_bf16 v27, v61, v61, v27
    v_dot2_f32_bf16 v26, v62, v62, v26
    v_dot2_f32_bf16 v27, v63, v63, v27
    ds_read_b128 v[92:95], v1 offset:44032
    s_waitcnt lgkmcnt(7)
    v_dot2_f32_bf16 v26, v64, v64, v26
    v_dot2_f32_bf16 v27, v65, v65, v27
    v_dot2_f32_bf16 v26, v66, v66, v26
    v_dot2_f32_bf16 v27, v67, v67, v27
    ds_read_b128 v[48:51], v1 offset:45056
    s_waitcnt lgkmcnt(7)
    v_dot2_f32_bf16 v26, v68, v68, v26
    v_dot2_f32_bf16 v27, v69, v69, v27
    v_dot2_f32_bf16 v26, v70, v70, v26
    v_dot2_f32_bf16 v27, v71, v71, v27
    ds_read_b128 v[52:55], v1 offset:46080
    s_waitcnt lgkmcnt(7)
    v_dot2_f32_bf16 v26, v72, v72, v26
    v_dot2_f32_bf16 v27, v73, v73, v27
    v_dot2_f32_bf16 v26, v74, v74, v26
    v_dot2_f32_bf16 v27, v75, v75, v27
    ds_read_b128 v[56:59], v1 offset:47104
    s_waitcnt lgkmcnt(7)
    v_dot2_f32_bf16 v26, v76, v76, v26
    v_dot2_f32_bf16 v27, v77, v77, v27
    v_dot2_f32_bf16 v26, v78, v78, v26
    v_dot2_f32_bf16 v27, v79, v79, v27
    ds_read_b128 v[60:63], v1 offset:48128
    s_waitcnt lgkmcnt(7)
    v_dot2_f32_bf16 v26, v80, v80, v26
    v_dot2_f32_bf16 v27, v81, v81, v27
    v_dot2_f32_bf16 v26, v82, v82, v26
    v_dot2_f32_bf16 v27, v83, v83, v27
    ds_read_b128 v[64:67], v1 offset:49152
    s_waitcnt lgkmcnt(7)
    v_dot2_f32_bf16 v26, v84, v84, v26
    v_dot2_f32_bf16 v27, v85, v85, v27
    v_dot2_f32_bf16 v26, v86, v86, v26
    v_dot2_f32_bf16 v27, v87, v87, v27
    ds_read_b128 v[68:71], v1 offset:50176
    s_waitcnt lgkmcnt(7)
    v_dot2_f32_bf16 v26, v88, v88, v26
    v_dot2_f32_bf16 v27, v89, v89, v27
    v_dot2_f32_bf16 v26, v90, v90, v26
    v_dot2_f32_bf16 v27, v91, v91, v27
    ds_read_b128 v[72:75], v1 offset:51200
    s_waitcnt lgkmcnt(7)
    v_dot2_f32_bf16 v26, v92, v92, v26
    v_dot2_f32_bf16 v27, v93, v93, v27
    v_dot2_f32_bf16 v26, v94, v94, v26
    v_dot2_f32_bf16 v27, v95, v95, v27
    ds_read_b128 v[76:79], v1 offset:52224
    s_waitcnt lgkmcnt(7)
    v_dot2_f32_bf16 v26, v48, v48, v26
    v_dot2_f32_bf16 v27, v49, v49, v27
    v_dot2_f32_bf16 v26, v50, v50, v26
    v_dot2_f32_bf16 v27, v51, v51, v27
    ds_read_b128 v[80:83], v1 offset:53248
    s_waitcnt lgkmcnt(7)
    v_dot2_f32_bf16 v26, v52, v52, v26
    v_dot2_f32_bf16 v27, v53, v53, v27
    v_dot2_f32_bf16 v26, v54, v54, v26
    v_dot2_f32_bf16 v27, v55, v55, v27
    ds_read_b128 v[84:87], v1 offset:54272
    s_waitcnt lgkmcnt(7)
    v_dot2_f32_bf16 v26, v56, v56, v26
    v_dot2_f32_bf16 v27, v57, v57, v27
    v_dot2_f32_bf16 v26, v58, v58, v26
    v_dot2_f32_bf16 v27, v59, v59, v27
    ds_read_b128 v[88:91], v1 offset:55296
    s_waitcnt lgkmcnt(7)
    v_dot2_f32_bf16 v26, v60, v60, v26
    v_dot2_f32_bf16 v27, v61, v61, v27
    v_dot2_f32_bf16 v26, v62, v62, v26
    v_dot2_f32_bf16 v27, v63, v63, v27
    ds_read_b128 v[92:95], v1 offset:56320
    s_waitcnt lgkmcnt(7)
    v_dot2_f32_bf16 v26, v64, v64, v26
    v_dot2_f32_bf16 v27, v65, v65, v27
    v_dot2_f32_bf16 v26, v66, v66, v26
    v_dot2_f32_bf16 v27, v67, v67, v27
    ds_read_b128 v[48:51], v1 offset:57344
    s_waitcnt lgkmcnt(7)
    v_dot2_f32_bf16 v26, v68, v68, v26
    v_dot2_f32_bf16 v27, v69, v69, v27
    v_dot2_f32_bf16 v26, v70, v70, v26
    v_dot2_f32_bf16 v27, v71, v71, v27
    ds_read_b128 v[52:55], v1 offset:58368
    s_waitcnt lgkmcnt(7)
    v_dot2_f32_bf16 v26, v72, v72, v26
    v_dot2_f32_bf16 v27, v73, v73, v27
    v_dot2_f32_bf16 v26, v74, v74, v26
    v_dot2_f32_bf16 v27, v75, v75, v27
    ds_read_b128 v[56:59], v1 offset:59392
    s_waitcnt lgkmcnt(7)
    v_dot2_f32_bf16 v26, v76, v76, v26
    v_dot2_f32_bf16 v27, v77, v77, v27
    v_dot2_f32_bf16 v26, v78, v78, v26
    v_dot2_f32_bf16 v27, v79, v79, v27
    ds_read_b128 v[60:63], v1 offset:60416
    s_waitcnt lgkmcnt(7)
    v_dot2_f32_bf16 v26, v80, v80, v26
    v_dot2_f32_bf16 v27, v81, v81, v27
    v_dot2_f32_bf16 v26, v82, v82, v26
    v_dot2_f32_bf16 v27, v83, v83, v27
    ds_read_b128 v[64:67], v1 offset:61440
    s_waitcnt lgkmcnt(7)
    v_dot2_f32_bf16 v26, v84, v84, v26
    v_dot2_f32_bf16 v27, v85, v85, v27
    v_dot2_f32_bf16 v26, v86, v86, v26
    v_dot2_f32_bf16 v27, v87, v87, v27
    ds_read_b128 v[68:71], v1 offset:62464
    s_waitcnt lgkmcnt(7)
    v_dot2_f32_bf16 v26, v88, v88, v26
    v_dot2_f32_bf16 v27, v89, v89, v27
    v_dot2_f32_bf16 v26, v90, v90, v26
    v_dot2_f32_bf16 v27, v91, v91, v27
    ds_read_b128 v[72:75], v1 offset:63488
    s_waitcnt lgkmcnt(7)
    v_dot2_f32_bf16 v26, v92, v92, v26
    v_dot2_f32_bf16 v27, v93, v93, v27
    v_dot2_f32_bf16 v26, v94, v94, v26
    v_dot2_f32_bf16 v27, v95, v95, v27
    ds_read_b128 v[76:79], v1 offset:64512
    s_waitcnt lgkmcnt(7)
    v_dot2_f32_bf16 v26, v48, v48, v26
    v_dot2_f32_bf16 v27, v49, v49, v27
    v_dot2_f32_bf16 v26, v50, v50, v26
    v_dot2_f32_bf16 v27, v51, v51, v27
    s_waitcnt lgkmcnt(6)
    v_dot2_f32_bf16 v26, v52, v52, v26
    v_dot2_f32_bf16 v27, v53, v53, v27
    v_dot2_f32_bf16 v26, v54, v54, v26
    v_dot2_f32_bf16 v27, v55, v55, v27
    s_waitcnt lgkmcnt(5)
    v_dot2_f32_bf16 v26, v56, v56, v26
    v_dot2_f32_bf16 v27, v57, v57, v27
    v_dot2_f32_bf16 v26, v58, v58, v26
    v_dot2_f32_bf16 v27, v59, v59, v27
    s_waitcnt lgkmcnt(4)
    v_dot2_f32_bf16 v26, v60, v60, v26
    v_dot2_f32_bf16 v27, v61, v61, v27
    v_dot2_f32_bf16 v26, v62, v62, v26
    v_dot2_f32_bf16 v27, v63, v63, v27
    s_waitcnt lgkmcnt(3)
    v_dot2_f32_bf16 v26, v64, v64, v26
    v_dot2_f32_bf16 v27, v65, v65, v27
    v_dot2_f32_bf16 v26, v66, v66, v26
    v_dot2_f32_bf16 v27, v67, v67, v27
    s_waitcnt lgkmcnt(2)
    v_dot2_f32_bf16 v26, v68, v68, v26
    v_dot2_f32_bf16 v27, v69, v69, v27
    v_dot2_f32_bf16 v26, v70, v70, v26
    v_dot2_f32_bf16 v27, v71, v71, v27
    s_waitcnt lgkmcnt(1)
    v_dot2_f32_bf16 v26, v72, v72, v26
    v_dot2_f32_bf16 v27, v73, v73, v27
    v_dot2_f32_bf16 v26, v74, v74, v26
    v_dot2_f32_bf16 v27, v75, v75, v27
    s_waitcnt lgkmcnt(0)
    v_dot2_f32_bf16 v26, v76, v76, v26
    v_dot2_f32_bf16 v27, v77, v77, v27
    v_dot2_f32_bf16 v26, v78, v78, v26
    v_dot2_f32_bf16 v27, v79, v79, v27
    v_add_f32 v24, v24, v25
    v_mov_b32 v25, v24
    s_nop 1
    v_permlane32_swap_b32 v24, v25
    v_add_f32 v24, v24, v25
    v_mul_f32 v24, 0x3b000000, v24
    v_fma_f32 v24, -v17, v17, v24
    v_max_f32 v24, 0, v24
    v_add_f32 v24, 0x3727c5ac, v24
    v_rsq_f32 v24, v24
    ds_write_b32 v137, v24 offset:4
    v_add_f32 v26, v26, v27
    v_mov_b32 v27, v26
    s_nop 1
    v_permlane32_swap_b32 v26, v27
    v_add_f32 v26, v26, v27
    v_mul_f32 v26, 0x3b000000, v26
    v_fma_f32 v26, -v21, v21, v26
    v_max_f32 v26, 0, v26
    v_add_f32 v26, 0x3727c5ac, v26
    v_rsq_f32 v26, v26
    ds_write_b32 v137, v26 offset:260
    s_waitcnt lgkmcnt(0)
    s_setprio 0
    s_nop 1
    s_add_u32 s79, s63, 1
    v_and_b32 v12, 7, v0
    v_min_u32 v12, 6, v12
    v_add_u32 v12, s79, v12
    v_and_b32 v12, 7, v12
    v_lshlrev_b32 v12, 7, v12
    s_and_b32 s79, s79, 7
    s_lshl_b32 s76, s62, 10
    s_add_u32 s76, s76, 73752
    buffer_load_dword v14, v12, s[36:39], s76 offen sc1
    s_lshl_b32 s77, s65, 8
    v_add_u32 v137, s77, v137
    s_mul_i32 s86, s79, 14336
    s_mul_i32 s77, s62, 229376
    s_add_u32 s77, s77, 4468736
    s_mul_i32 s78, s65, 114688
    s_add_u32 s78, s78, s77
    s_xor_b32 s79, s65, 1
    s_mul_i32 s79, s79, 114688
    s_add_u32 s77, s77, s79
    s_lshl_b32 s79, s64, 11
    v_add_u32 v10, s79, v1
    v_add_u32 v11, 0x10000, v10
    s_barrier
    s_waitcnt vmcnt(0)
    v_cmp_ne_u32 vcc, s69, v14
    s_nop 0
    s_cbranch_vccz L_seen_28
    s_mov_b32 s74, 65536
L_poll_27:
    buffer_load_dword v14, v12, s[36:39], s76 offen sc1
    s_waitcnt vmcnt(0)
    v_cmp_ne_u32 vcc, s69, v14
    s_nop 0
    s_cbranch_vccz L_seen_28
    s_sub_u32 s74, s74, 1
    s_cbranch_scc0 L_poll_27
L_seen_28:
    s_mov_b32 s82, s86
    s_add_u32 s76, s77, s82
    buffer_load_dwordx4 v[80:83], v1, s[36:39], s76 offen offset:0 sc1
    buffer_load_dwordx4 v[84:87], v1, s[36:39], s76 offen offset:1024 sc1
    s_add_u32 s82, s82, 14336
    s_sub_u32 s79, s82, 114688
    s_cselect_b32 s82, s82, s79
    s_add_u32 s76, s77, s82
    buffer_load_dwordx4 v[88:91], v1, s[36:39], s76 offen offset:0 sc1
    buffer_load_dwordx4 v[92:95], v1, s[36:39], s76 offen offset:1024 sc1
    s_add_u32 s82, s82, 14336
    s_sub_u32 s79, s82, 114688
    s_cselect_b32 s82, s82, s79
    s_add_u32 s76, s77, s82
    buffer_load_dwordx4 v[96:99], v1, s[36:39], s76 offen offset:0 sc1
    buffer_load_dwordx4 v[100:103], v1, s[36:39], s76 offen offset:1024 sc1
    s_add_u32 s82, s82, 14336
    s_sub_u32 s79, s82, 114688
    s_cselect_b32 s82, s82, s79
    s_add_u32 s76, s77, s82
    buffer_load_dwordx4 v[104:107], v1, s[36:39], s76 offen offset:0 sc1
    buffer_load_dwordx4 v[108:111], v1, s[36:39], s76 offen offset:1024 sc1
    s_add_u32 s82, s82, 14336
    s_sub_u32 s79, s82, 114688
    s_cselect_b32 s82, s82, s79
    s_add_u32 s76, s77, s82
    buffer_load_dwordx4 v[112:115], v1, s[36:39], s76 offen offset:0 sc1
    buffer_load_dwordx4 v[116:119], v1, s[36:39], s76 offen offset:1024 sc1
    s_add_u32 s82, s82, 14336
    s_sub_u32 s79, s82, 114688
    s_cselect_b32 s82, s82, s79
    s_add_u32 s76, s77, s82
    buffer_load_dwordx4 v[120:123], v1, s[36:39], s76 offen offset:0 sc1
    buffer_load_dwordx4 v[124:127], v1, s[36:39], s76 offen offset:1024 sc1
    s_add_u32 s82, s82, 14336
    s_sub_u32 s79, s82, 114688
    s_cselect_b32 s82, s82, s79
    s_add_u32 s76, s77, s82
    buffer_load_dwordx4 v[128:131], v1, s[36:39], s76 offen offset:0 sc1
    buffer_load_dwordx4 v[132:135], v1, s[36:39], s76 offen offset:1024 sc1
    ds_read_b32 v136, v137 offset:4
    s_waitcnt vmcnt(13)
    v_mfma_f32_32x32x16_bf16 v[32:47], v[200:203], v[80:83], 0
    v_mfma_f32_32x32x16_bf16 v[16:31], v[144:147], v[80:83], 0
    s_waitcnt vmcnt(12)
    v_mfma_f32_32x32x16_bf16 v[32:47], v[204:207], v[84:87], v[32:47]
    v_mfma_f32_32x32x16_bf16 v[16:31], v[148:151], v[84:87], v[16:31]
    s_mov_b32 s82, s86
    s_add_u32 s76, s78, s82
    buffer_load_dwordx4 v[80:83], v1, s[36:39], s76 offen offset:0 sc1
    s_waitcnt vmcnt(12)
    v_mfma_f32_32x32x16_bf16 v[32:47], v[208:211], v[88:91], v[32:47]
    v_mfma_f32_32x32x16_bf16 v[16:31], v[152:155], v[88:91], v[16:31]
    buffer_load_dwordx4 v[84:87], v1, s[36:39], s76 offen offset:1024 sc1
    s_waitcnt vmcnt(12)
    v_mfma_f32_32x32x16_bf16 v[32:47], v[212:215], v[92:95], v[32:47]
    v_mfma_f32_32x32x16_bf16 v[16:31], v[156:159], v[92:95], v[16:31]
    s_add_u32 s82, s82, 14336
    s_sub_u32 s79, s82, 114688
    s_cselect_b32 s82, s82, s79
    s_add_u32 s76, s78, s82
    buffer_load_dwordx4 v[88:91], v1, s[36:39], s76 offen offset:0 sc1
    s_waitcnt vmcnt(12)
    v_mfma_f32_32x32x16_bf16 v[32:47], v[216:219], v[96:99], v[32:47]
    v_mfma_f32_32x32x16_bf16 v[16:31], v[160:163], v[96:99], v[16:31]
    buffer_load_dwordx4 v[92:95], v1, s[36:39], s76 offen offset:1024 sc1
    s_waitcnt vmcnt(12)
    v_mfma_f32_32x32x16_bf16 v[32:47], v[220:223], v[100:103], v[32:47]
    v_mfma_f32_32x32x16_bf16 v[16:31], v[164:167], v[100:103], v[16:31]
    s_add_u32 s82, s82, 14336
    s_sub_u32 s79, s82, 114688
    s_cselect_b32 s82, s82, s79
    s_add_u32 s76, s78, s82
    buffer_load_dwordx4 v[96:99], v1, s[36:39], s76 offen offset:0 sc1
    s_waitcnt vmcnt(12)
    v_mfma_f32_32x32x16_bf16 v[32:47], v[224:227], v[104:107], v[32:47]
    v_mfma_f32_32x32x16_bf16 v[16:31], v[168:171], v[104:107], v[16:31]
    buffer_load_dwordx4 v[100:103], v1, s[36:39], s76 offen offset:1024 sc1
    s_waitcnt vmcnt(12)
    v_mfma_f32_32x32x16_bf16 v[32:47], v[228:231], v[108:111], v[32:47]
    v_mfma_f32_32x32x16_bf16 v[16:31], v[172:175], v[108:111], v[16:31]
    s_add_u32 s82, s82, 14336
    s_sub_u32 s79, s82, 114688
    s_cselect_b32 s82, s82, s79
    s_add_u32 s76, s78, s82
    buffer_load_dwordx4 v[104:107], v1, s[36:39], s76 offen offset:0 sc1
    s_waitcnt vmcnt(12)
    v_mfma_f32_32x32x16_bf16 v[32:47], v[232:235], v[112:115], v[32:47]
    v_mfma_f32_32x32x16_bf16 v[16:31], v[176:179], v[112:115], v[16:31]
    buffer_load_dwordx4 v[108:111], v1, s[36:39], s76 offen offset:1024 sc1
    s_waitcnt vmcnt(12)
    v_mfma_f32_32x32x16_bf16 v[32:47], v[236:239], v[116:119], v[32:47]
    v_mfma_f32_32x32x16_bf16 v[16:31], v[180:183], v[116:119], v[16:31]
    s_add_u32 s82, s82, 14336
    s_sub_u32 s79, s82, 114688
    s_cselect_b32 s82, s82, s79
    s_add_u32 s76, s78, s82
    buffer_load_dwordx4 v[112:115], v1, s[36:39], s76 offen offset:0 sc1
    s_waitcnt vmcnt(12)
    v_mfma_f32_32x32x16_bf16 v[32:47], v[240:243], v[120:123], v[32:47]
    v_mfma_f32_32x32x16_bf16 v[16:31], v[184:187], v[120:123], v[16:31]
    buffer_load_dwordx4 v[116:119], v1, s[36:39], s76 offen offset:1024 sc1
    s_waitcnt vmcnt(12)
    v_mfma_f32_32x32x16_bf16 v[32:47], v[244:247], v[124:127], v[32:47]
    v_mfma_f32_32x32x16_bf16 v[16:31], v[188:191], v[124:127], v[16:31]
    s_add_u32 s82, s82, 14336
    s_sub_u32 s79, s82, 114688
    s_cselect_b32 s82, s82, s79
    s_add_u32 s76, s78, s82
    buffer_load_dwordx4 v[120:123], v1, s[36:39], s76 offen offset:0 sc1
    s_waitcnt vmcnt(12)
    v_mfma_f32_32x32x16_bf16 v[32:47], v[248:251], v[128:131], v[32:47]
    v_mfma_f32_32x32x16_bf16 v[16:31], v[192:195], v[128:131], v[16:31]
    buffer_load_dwordx4 v[124:127], v1, s[36:39], s76 offen offset:1024 sc1
    s_waitcnt vmcnt(12)
    v_mfma_f32_32x32x16_bf16 v[32:47], v[252:255], v[132:135], v[32:47]
    v_mfma_f32_32x32x16_bf16 v[16:31], v[196:199], v[132:135], v[16:31]
    s_add_u32 s82, s82, 14336
    s_sub_u32 s79, s82, 114688
    s_cselect_b32 s82, s82, s79
    s_add_u32 s76, s78, s82
    buffer_load_dwordx4 v[128:131], v1, s[36:39], s76 offen offset:0 sc1
    s_nop 3
    buffer_load_dwordx4 v[132:135], v1, s[36:39], s76 offen offset:1024 sc1
    s_waitcnt vmcnt(13)
    v_mfma_f32_32x32x16_bf16 v[64:79], v[200:203], v[80:83], 0
    v_mfma_f32_32x32x16_bf16 v[48:63], v[144:147], v[80:83], 0
    s_waitcnt vmcnt(12)
    v_mfma_f32_32x32x16_bf16 v[64:79], v[204:207], v[84:87], v[64:79]
    v_mfma_f32_32x32x16_bf16 v[48:63], v[148:151], v[84:87], v[48:63]
    s_waitcnt vmcnt(11)
    v_mfma_f32_32x32x16_bf16 v[64:79], v[208:211], v[88:91], v[64:79]
    v_mfma_f32_32x32x16_bf16 v[48:63], v[152:155], v[88:91], v[48:63]
    ds_write_b128 v11, v[32:35] offset:0
    ds_write_b128 v11, v[36:39] offset:1024
    s_waitcnt vmcnt(10)
    v_mfma_f32_32x32x16_bf16 v[64:79], v[212:215], v[92:95], v[64:79]
    v_mfma_f32_32x32x16_bf16 v[48:63], v[156:159], v[92:95], v[48:63]
    s_waitcnt vmcnt(9)
    v_mfma_f32_32x32x16_bf16 v[64:79], v[216:219], v[96:99], v[64:79]
    v_mfma_f32_32x32x16_bf16 v[48:63], v[160:163], v[96:99], v[48:63]
    ds_write_b128 v11, v[40:43] offset:32768
    ds_write_b128 v11, v[44:47] offset:33792
    s_waitcnt vmcnt(8)
    v_mfma_f32_32x32x16_bf16 v[64:79], v[220:223], v[100:103], v[64:79]
    v_mfma_f32_32x32x16_bf16 v[48:63], v[164:167], v[100:103], v[48:63]
    s_waitcnt vmcnt(7)
    v_mfma_f32_32x32x16_bf16 v[64:79], v[224:227], v[104:107], v[64:79]
    v_mfma_f32_32x32x16_bf16 v[48:63], v[168:171], v[104:107], v[48:63]
    ds_write_b128 v10, v[16:19] offset:0
    ds_write_b128 v10, v[20:23] offset:1024
    s_waitcnt vmcnt(6)
    v_mfma_f32_32x32x16_bf16 v[64:79], v[228:231], v[108:111], v[64:79]
    v_mfma_f32_32x32x16_bf16 v[48:63], v[172:175], v[108:111], v[48:63]
    s_waitcnt vmcnt(5)
    v_mfma_f32_32x32x16_bf16 v[64:79], v[232:235], v[112:115], v[64:79]
    v_mfma_f32_32x32x16_bf16 v[48:63], v[176:179], v[112:115], v[48:63]
    ds_write_b128 v10, v[24:27] offset:32768
    ds_write_b128 v10, v[28:31] offset:33792
    s_waitcnt vmcnt(4)
    v_mfma_f32_32x32x16_bf16 v[64:79], v[236:239], v[116:119], v[64:79]
    v_mfma_f32_32x32x16_bf16 v[48:63], v[180:183], v[116:119], v[48:63]
    s_waitcnt vmcnt(3)
    v_mfma_f32_32x32x16_bf16 v[64:79], v[240:243], v[120:123], v[64:79]
    v_mfma_f32_32x32x16_bf16 v[48:63], v[184:187], v[120:123], v[48:63]
    s_waitcnt vmcnt(2)
    v_mfma_f32_32x32x16_bf16 v[64:79], v[244:247], v[124:127], v[64:79]
    v_mfma_f32_32x32x16_bf16 v[48:63], v[188:191], v[124:127], v[48:63]
    s_waitcnt vmcnt(1)
    v_mfma_f32_32x32x16_bf16 v[64:79], v[248:251], v[128:131], v[64:79]
    v_mfma_f32_32x32x16_bf16 v[48:63], v[192:195], v[128:131], v[48:63]
    s_waitcnt vmcnt(0)
    v_mfma_f32_32x32x16_bf16 v[64:79], v[252:255], v[132:135], v[64:79]
    v_mfma_f32_32x32x16_bf16 v[48:63], v[196:199], v[132:135], v[48:63]
    s_waitcnt lgkmcnt(0)
    s_nop 1
    s_branch L_ffn2_done
L_fallback:
    s_waitcnt lgkmcnt(0)
    s_barrier
    s_mov_b32 s75, 1
    v_mov_b32 v10, 0xff800000
    v_mov_b32 v11, 0xff800000
    s_mov_b32 s81, 131072
L_fb1:
    buffer_load_dwordx4 v[88:91], v4, s[36:39], s81 offen sc1
    s_waitcnt vmcnt(0)
    v_mfma_f32_32x32x16_bf16 v[24:39], v[88:91], v[16:19], 0
    s_nop 11
    v_max3_f32 v10, v24, v25, v10
    v_max3_f32 v10, v26, v27, v10
    v_max3_f32 v10, v28, v29, v10
    v_max3_f32 v10, v30, v31, v10
    v_max3_f32 v10, v32, v33, v10
    v_max3_f32 v10, v34, v35, v10
    v_max3_f32 v10, v36, v37, v10
    v_max3_f32 v10, v38, v39, v10
    v_mfma_f32_32x32x16_bf16 v[24:39], v[88:91], v[20:23], 0
    s_nop 11
    v_max3_f32 v11, v24, v25, v11
    v_max3_f32 v11, v26, v27, v11
    v_max3_f32 v11, v28, v29, v11
    v_max3_f32 v11, v30, v31, v11
    v_max3_f32 v11, v32, v33, v11
    v_max3_f32 v11, v34, v35, v11
    v_max3_f32 v11, v36, v37, v11
    v_max3_f32 v11, v38, v39, v11
    s_add_u32 s81, s81, 2048
    s_cmp_lt_u32 s81, 262144
    s_cbranch_scc1 L_fb1
    v_mov_b32 v12, v10
    s_nop 1
    v_permlane32_swap_b32 v12, v10
    v_max_f32 v10, v10, v12
    v_mov_b32 v12, v11
    s_nop 1
    v_permlane32_swap_b32 v12, v11
    v_max_f32 v11, v11, v12
    v_mov_b32 v56, 0
    v_mov_b32 v57, 0
    v_mov_b32 v58, 0
    v_mov_b32 v59, 0
    v_mov_b32 v60, 0
    v_mov_b32 v61, 0
    v_mov_b32 v62, 0
    v_mov_b32 v63, 0
    v_mov_b32 v64, 0
    v_mov_b32 v65, 0
    v_mov_b32 v66, 0
    v_mov_b32 v67, 0
    v_mov_b32 v68, 0
    v_mov_b32 v69, 0
    v_mov_b32 v70, 0
    v_mov_b32 v71, 0
    v_mov_b32 v72, 0
    v_mov_b32 v73, 0
    v_mov_b32 v74, 0
    v_mov_b32 v75, 0
    v_mov_b32 v76, 0
    v_mov_b32 v77, 0
    v_mov_b32 v78, 0
    v_mov_b32 v79, 0
    v_mov_b32 v80, 0
    v_mov_b32 v81, 0
    v_mov_b32 v82, 0
    v_mov_b32 v83, 0
    v_mov_b32 v84, 0
    v_mov_b32 v85, 0
    v_mov_b32 v86, 0
    v_mov_b32 v87, 0
    s_lshl_b32 s81, s67, 16
    s_add_u32 s81, s81, 131072
    s_add_u32 s76, s81, 0x10000
L_fb2:
    s_nop 11
    buffer_load_dwordx4 v[88:91], v4, s[36:39], s81 offen sc1
    s_mov_b64 exec, s[88:89]
    buffer_load_dwordx4 v[92:95], v5, s[36:39], s81 offen offset:1024 sc1
    buffer_load_dwordx4 v[96:99], v5, s[36:39], s81 offen offset:1536 sc1
    s_mov_b64 exec, -1
    s_waitcnt vmcnt(0)
    v_mfma_f32_32x32x16_bf16 v[24:39], v[88:91], v[16:19], 0
    s_nop 11
    v_sub_f32 v24, v24, v10
    v_sub_f32 v25, v25, v10
    v_sub_f32 v26, v26, v10
    v_sub_f32 v27, v27, v10
    v_sub_f32 v28, v28, v10
    v_sub_f32 v29, v29, v10
    v_sub_f32 v30, v30, v10
    v_sub_f32 v31, v31, v10
    v_sub_f32 v32, v32, v10
    v_sub_f32 v33, v33, v10
    v_sub_f32 v34, v34, v10
    v_sub_f32 v35, v35, v10
    v_sub_f32 v36, v36, v10
    v_sub_f32 v37, v37, v10
    v_sub_f32 v38, v38, v10
    v_sub_f32 v39, v39, v10
    v_exp_f32 v24, v24
    v_exp_f32 v25, v25
    v_exp_f32 v26, v26
    v_exp_f32 v27, v27
    v_exp_f32 v28, v28
    v_exp_f32 v29, v29
    v_exp_f32 v30, v30
    v_exp_f32 v31, v31
    v_exp_f32 v32, v32
    v_exp_f32 v33, v33
    v_exp_f32 v34, v34
    v_exp_f32 v35, v35
    v_exp_f32 v36, v36
    v_exp_f32 v37, v37
    v_exp_f32 v38, v38
    v_exp_f32 v39, v39
    v_smfmac_f32_32x32x32_bf16 v[56:71], v[92:95], v[24:31], v6
    s_nop 0
    v_smfmac_f32_32x32x32_bf16 v[56:71], v[96:99], v[32:39], v6
    v_mfma_f32_32x32x16_bf16 v[40:55], v[88:91], v[20:23], 0
    s_nop 11
    v_sub_f32 v40, v40, v11
    v_sub_f32 v41, v41, v11
    v_sub_f32 v42, v42, v11
    v_sub_f32 v43, v43, v11
    v_sub_f32 v44, v44, v11
    v_sub_f32 v45, v45, v11
    v_sub_f32 v46, v46, v11
    v_sub_f32 v47, v47, v11
    v_sub_f32 v48, v48, v11
    v_sub_f32 v49, v49, v11
    v_sub_f32 v50, v50, v11
    v_sub_f32 v51, v51, v11
    v_sub_f32 v52, v52, v11
    v_sub_f32 v53, v53, v11
    v_sub_f32 v54, v54, v11
    v_sub_f32 v55, v55, v11
    v_exp_f32 v40, v40
    v_exp_f32 v41, v41
    v_exp_f32 v42, v42
    v_exp_f32 v43, v43
    v_exp_f32 v44, v44
    v_exp_f32 v45, v45
    v_exp_f32 v46, v46
    v_exp_f32 v47, v47
    v_exp_f32 v48, v48
    v_exp_f32 v49, v49
    v_exp_f32 v50, v50
    v_exp_f32 v51, v51
    v_exp_f32 v52, v52
    v_exp_f32 v53, v53
    v_exp_f32 v54, v54
    v_exp_f32 v55, v55
    v_smfmac_f32_32x32x32_bf16 v[72:87], v[92:95], v[40:47], v6
    s_nop 0
    v_smfmac_f32_32x32x32_bf16 v[72:87], v[96:99], v[48:55], v6
    s_add_u32 s81, s81, 2048
    s_cmp_lt_u32 s81, s76
    s_cbranch_scc1 L_fb2
    s_branch L_attn_done
L_end:
    s_endpgm
.section .rodata,"a"
.p2align 6
.amdhsa_kernel sequential_preLN__grouped_kv_mqa__dense_activation_relu__prompt_kernel
  .amdhsa_next_free_vgpr 256
  .amdhsa_next_free_sgpr 102
  .amdhsa_accum_offset 256
  .amdhsa_group_segment_fixed_size 0
  .amdhsa_kernarg_size 88
  .amdhsa_user_sgpr_count 2
  .amdhsa_user_sgpr_kernarg_segment_ptr 1
  .amdhsa_system_sgpr_workgroup_id_x 1
.end_amdhsa_kernel
```
